```python
import torch

def _softmax(x, axis=-1):
    return torch.softmax(x, dim=axis)
def _gelu(x):
    return torch.nn.functional.gelu(x, approximate="tanh")
def _silu(x):
    return torch.nn.functional.silu(x)
def _sigmoid(x):
    return torch.sigmoid(x)
def _layernorm(x, axis=-1, eps=1e-5):
    m = x.mean(dim=axis, keepdim=True)
    v = x.var(dim=axis, keepdim=True, unbiased=False)
    return (x - m) / torch.sqrt(v + eps)
def _scatter_add(tgt, idx, src, axis=0):
    return tgt.clone().index_add_(axis, idx, src)
def _segment_sum(src, seg, n):
    out = torch.zeros((n,) + src.shape[1:], dtype=src.dtype)
    return out.index_add_(0, seg, src)
def _pad(x, pw):
    flat = tuple(v for pair in reversed(pw) for v in pair)
    return torch.nn.functional.pad(x, flat)

kernel_name = 'parallel_sum__mha_block_cached__geglu_ffn__decode'

def setup_inputs():

    _w = (lambda a: (lambda t: t.to(torch.bfloat16) if t.is_floating_point() else t)(torch.as_tensor(a)))
    def _A_setup():
        B, Sq, D = 2, 1, 640
        H, Sk, Dh = 32, 4096, 192
        return {
            "x": _w((lambda *s: torch.randn(*s, dtype=torch.bfloat16) * 0.05)(B, Sq, D)),
            "k_cache": _w((lambda *s: torch.randn(*s, dtype=torch.bfloat16) * 3.2)(B, H, Sk, Dh)),
            "v_cache": _w((lambda *s: torch.randn(*s, dtype=torch.bfloat16) * 1.6)(B, H, Sk, Dh)),
            "wq": _w((lambda *s: torch.randn(*s, dtype=torch.bfloat16) * 3.2)(D, H * Dh) * (D ** -0.5)),
            "wo": _w((lambda *s: torch.randn(*s, dtype=torch.bfloat16) * 1.6)(H * Dh, D) * ((H * Dh) ** -0.5)),
        }
    _A_in = _A_setup()

    def _B_setup():
        B, S, D, F = 2, 1, 640, 1536
        return {
            "x": _w((lambda *s: torch.randn(*s, dtype=torch.bfloat16) * 0.05)(B, S, D)),
            "w_gate": _w((lambda *s: torch.randn(*s, dtype=torch.bfloat16) * 0.05)(D, F)),
            "w_up": _w((lambda *s: torch.randn(*s, dtype=torch.bfloat16) * 0.05)(D, F)),
            "w_down": _w((lambda *s: torch.randn(*s, dtype=torch.bfloat16) * 0.05)(F, D)),
        }
    _B_in = _B_setup()

    return {
        "A_x": _A_in["x"],
        "A_k_cache": _A_in["k_cache"],
        "A_v_cache": _A_in["v_cache"],
        "A_wq": _A_in["wq"],
        "A_wo": _A_in["wo"],
        "B_x": _B_in["x"],
        "B_w_gate": _B_in["w_gate"],
        "B_w_up": _B_in["w_up"],
        "B_w_down": _B_in["w_down"],
    }

def reference(A_x, A_k_cache, A_v_cache, A_wq, A_wo, B_x, B_w_gate, B_w_up, B_w_down):
    def _A_ref(x, k_cache, v_cache, wq, wo):
        B, Sq, D = x.shape
        H, Dh = 32, 192
        q = (lambda x, *d: x.permute(*d))((x @ wq).reshape(B, Sq, H, Dh), 0, 2, 1, 3)
        scores = torch.einsum("bhqd,bhkd->bhqk", q, k_cache) * (Dh ** -0.5)
        p = _softmax(scores, axis=-1)
        o = torch.einsum("bhqk,bhkd->bhqd", p, v_cache)
        return (lambda x, *d: x.permute(*d))(o, 0, 2, 1, 3).reshape(B, Sq, H * Dh) @ wo

    def _B_ref(x, w_gate, w_up, w_down):
        return (_gelu(x @ w_gate) * (x @ w_up)) @ w_down

    x = A_x
    xn = _layernorm(x, axis=-1)
    return x + _A_ref(xn, A_k_cache, A_v_cache, A_wq, A_wo) + _B_ref(xn, B_w_gate, B_w_up, B_w_down)
```

```asm
; @launch grid=(256,1,1) block=(512,1,1) lds=32768
.amdgcn_target "amdgcn-amd-amdhsa--gfx950"
.text
.globl parallel_sum__mha_block_cached__geglu_ffn__decode_kernel
.p2align 8
.type parallel_sum__mha_block_cached__geglu_ffn__decode_kernel,@function
parallel_sum__mha_block_cached__geglu_ffn__decode_kernel:
    s_cmpk_ge_u32 s2, 0x100
    s_cbranch_scc1 L_exit
    s_load_dwordx16 s[16:31], s[0:1], 0x0
    s_load_dwordx8 s[32:39], s[0:1], 0x40
    v_lshrrev_b32 v8, 6, v0
    v_and_b32 v1, 63, v0
    s_and_b32 s8, s2, 7
    v_readfirstlane_b32 s3, v8
    s_getreg_b32 s100, hwreg(HW_REG_XCC_ID)
    s_lshr_b32 s9, s2, 3
    s_and_b32 s10, s9, 3
    s_lshl2_add_u32 s4, s8, s10
    s_lshr_b32 s5, s9, 2
    s_and_b32 s6, s5, 1
    s_lshr_b32 s8, s5, 1
    s_lshl_b32 s9, s6, 5
    s_add_u32 s9, s9, s4
    s_lshl2_add_u32 s9, s9, s8
    s_mul_i32 s9, s9, 0x60000
    s_mul_i32 s10, s3, 3072
    s_add_u32 s9, s9, s10
    s_and_b32 s85, s2, 15
    s_mul_i32 s85, s85, 24576
    v_lshrrev_b32 v9, 3, v1
    v_and_b32 v10, 7, v1
    v_lshlrev_b32 v11, 4, v10
    v_mul_u32_u24 v2, 384, v9
    v_add_u32 v2, v2, v11
    v_lshlrev_b32 v7, 4, v1
    s_waitcnt lgkmcnt(0)
    s_load_dword s14, s[38:39], 0x0
    s_cmp_lt_u32 s3, 5
    s_cbranch_scc1 L_gemvld
    s_cmp_eq_u32 s3, 7
    s_cbranch_scc1 L_common
    s_setprio 3
    s_mov_b32 s64, s16
    s_mov_b32 s65, s17
    s_mov_b32 s66, 2560
    s_mov_b32 s67, 0x20000
    s_sub_u32 s10, s3, 5
    s_mul_i32 s10, s10, 1280
    v_lshlrev_b32 v12, 2, v1
    buffer_load_dword v116, v12, s[64:67], s10 offen offset:0
    buffer_load_dword v117, v12, s[64:67], s10 offen offset:256
    buffer_load_dword v118, v12, s[64:67], s10 offen offset:512
    buffer_load_dword v119, v12, s[64:67], s10 offen offset:768
    buffer_load_dword v120, v12, s[64:67], s10 offen offset:1024
    s_branch L_common
L_gemvld:
    s_setprio 2
    s_cmp_lt_u32 s3, 3
    s_cselect_b32 s10, 4, 1
    s_mul_i32 s77, s10, 3072
    s_mul_i32 s10, s10, 96
    s_cselect_b32 s11, 128, 0
    s_cselect_b64 s[82:83], -1, 0
    s_cselect_b32 s12, s22, s28
    s_cselect_b32 s13, s23, s29
    s_cmp_eq_u32 s3, 4
    s_cselect_b32 s12, s30, s12
    s_cselect_b32 s13, s31, s13
    s_or_b32 s82, s82, 0x3f3f3f3f
    s_or_b32 s83, s83, 0x3f3f3f3f
    s_mul_i32 s10, s10, s4
    s_mul_i32 s11, s11, s3
    s_add_u32 s10, s10, s11
    s_mul_i32 s11, s77, s5
    s_mul_i32 s11, s11, 80
    s_add_u32 s10, s10, s11
    s_add_u32 s48, s12, s10
    s_addc_u32 s49, s13, 0
    s_mul_i32 s50, s77, 80
    s_mov_b32 s51, 0x20000
    s_mul_i32 s11, s77, 10
    v_mul_u32_u24 v12, s11, v9
    v_add_u32 v12, v12, v11
    s_mov_b32 s10, 0
    s_mov_b64 exec, s[82:83]
    buffer_load_dwordx4 v[116:119], v12, s[48:51], s10 offen nt
    s_add_u32 s10, s10, s77
    buffer_load_dwordx4 v[120:123], v12, s[48:51], s10 offen nt
    s_add_u32 s10, s10, s77
    buffer_load_dwordx4 v[124:127], v12, s[48:51], s10 offen nt
    s_add_u32 s10, s10, s77
    buffer_load_dwordx4 v[128:131], v12, s[48:51], s10 offen nt
    s_add_u32 s10, s10, s77
    buffer_load_dwordx4 v[132:135], v12, s[48:51], s10 offen nt
    s_add_u32 s10, s10, s77
    buffer_load_dwordx4 v[136:139], v12, s[48:51], s10 offen nt
    s_add_u32 s10, s10, s77
    buffer_load_dwordx4 v[140:143], v12, s[48:51], s10 offen nt
    s_add_u32 s10, s10, s77
    buffer_load_dwordx4 v[144:147], v12, s[48:51], s10 offen nt
    s_add_u32 s10, s10, s77
    buffer_load_dwordx4 v[148:151], v12, s[48:51], s10 offen nt
    s_add_u32 s10, s10, s77
    buffer_load_dwordx4 v[152:155], v12, s[48:51], s10 offen nt
    s_mov_b64 exec, -1
L_common:
    s_add_u32 s40, s18, s9
    s_addc_u32 s41, s19, 0
    s_mov_b32 s42, 393216
    s_mov_b32 s43, 0x20000
    s_add_u32 s44, s20, s9
    s_addc_u32 s45, s21, 0
    s_mov_b32 s46, 393216
    s_mov_b32 s47, 0x20000
    s_mov_b32 s60, s38
    s_mov_b32 s61, s39
    s_mov_b32 s62, 4034560
    s_mov_b32 s63, 0x20000
    s_mov_b32 s73, 0x01000100
    s_mov_b32 s74, 0x03020302
    s_mov_b32 s75, 0x3d93cd3a
    s_mov_b32 s76, 0x3fb8aa3b
    s_mov_b32 s95, 0xffff0000
    s_mov_b32 s8, 0xffff
    v_and_b32 v13, 1, v1
    v_lshlrev_b32 v13, 4, v13
    v_lshlrev_b32 v13, v13, s8
    v_bfe_u32 v14, v1, 1, 2
    v_lshlrev_b32 v14, v14, 1
    v_bfe_i32 v15, v14, 0, 1
    v_and_b32 v3, v15, v13
    v_bfe_i32 v15, v14, 1, 1
    v_and_b32 v4, v15, v13
    v_bfe_i32 v15, v14, 2, 1
    v_and_b32 v5, v15, v13
    v_bfe_i32 v15, v14, 3, 1
    v_and_b32 v6, v15, v13
    s_lshl_b32 s8, s4, 1
    s_add_u32 s8, s8, 96
    s_lshl_b32 s8, s8, 3
    s_add_u32 s8, s8, s3
    s_lshl_b32 s8, s8, 10
    s_add_u32 s78, s8, 4096
    s_add_u32 s79, s78, 8192
    s_mul_i32 s8, s4, 192
    s_mul_i32 s9, s3, 24
    s_add_u32 s8, s8, s9
    s_mul_i32 s8, s8, 1280
    s_mul_i32 s10, s5, 160
    s_add_u32 s8, s8, s10
    s_add_u32 s52, s24, s8
    s_addc_u32 s53, s25, 0
    s_mov_b32 s54, 30720
    s_mov_b32 s55, 0x20000
    s_mul_i32 s8, s4, 48
    s_lshl_b32 s9, s3, 3
    s_add_u32 s8, s8, s9
    s_mul_i32 s8, s8, 1280
    s_add_u32 s8, s8, s10
    s_add_u32 s56, s32, s8
    s_addc_u32 s57, s33, 0
    s_mov_b32 s58, 10240
    s_mov_b32 s59, 0x20000
    v_lshrrev_b32 v14, 4, v1
    v_and_b32 v15, 15, v1
    v_lshlrev_b32 v15, 4, v15
    v_mul_u32_u24 v248, 7680, v14
    v_add_u32 v248, v248, v15
    v_mul_u32_u24 v249, 2560, v14
    v_add_u32 v249, v249, v15
    s_mov_b32 s64, s16
    s_mov_b32 s65, s17
    s_mov_b32 s66, 2560
    s_mov_b32 s67, 0x20000
    s_and_b32 s8, s4, 1
    s_mul_i32 s8, s8, 640
    s_bfe_u32 s9, s4, 0x30001
    s_mul_i32 s9, s9, 10
    s_add_u32 s8, s8, s9
    s_mul_i32 s9, s5, 80
    s_add_u32 s8, s8, s9
    s_lshl_b32 s84, s8, 1
    v_and_b32 v250, 7, v1
    v_min_u32 v250, 4, v250
    v_lshlrev_b32 v250, 2, v250
    s_cmp_eq_u32 s3, 7
    s_cbranch_scc0 L_not7
    v_mov_b32 v14, 0
    ds_write_b32 v14, v14 offset:3136
    ds_write_b32 v14, v14 offset:3144
    ds_write_b32 v14, v14 offset:3140
    ds_write_b32 v14, v14 offset:3148
    s_add_u32 s72, s85, 0
    s_sub_u32 s99, s72, 393216
    s_cselect_b32 s72, s72, s99
    buffer_load_dwordx4 v[176:179], v2, s[40:43], s72 offen nt
    buffer_load_dwordx4 v[180:183], v2, s[40:43], s72 offen offset:128 nt
    buffer_load_dwordx4 v[184:187], v2, s[40:43], s72 offen offset:256 nt
    s_branch L_b1
L_not7:
    s_cmp_lt_u32 s3, 5
    s_cbranch_scc0 L_ln
    s_branch L_b1
L_ln:
    s_sub_u32 s10, s3, 5
    s_waitcnt vmcnt(0)
    v_lshlrev_b32 v124, 16, v116
    v_and_b32 v125, s95, v116
    v_lshlrev_b32 v126, 16, v117
    v_and_b32 v127, s95, v117
    v_lshlrev_b32 v128, 16, v118
    v_and_b32 v129, s95, v118
    v_lshlrev_b32 v130, 16, v119
    v_and_b32 v131, s95, v119
    v_lshlrev_b32 v132, 16, v120
    v_and_b32 v133, s95, v120
    v_add_f32 v16, v124, v125
    v_add_f32 v16, v16, v126
    v_add_f32 v16, v16, v127
    v_add_f32 v16, v16, v128
    v_add_f32 v16, v16, v129
    v_add_f32 v16, v16, v130
    v_add_f32 v16, v16, v131
    v_add_f32 v16, v16, v132
    v_add_f32 v16, v16, v133
    s_nop 1
    v_add_f32_dpp v16, v16, v16 quad_perm:[1,0,3,2] row_mask:0xf bank_mask:0xf
    s_nop 1
    v_add_f32_dpp v16, v16, v16 quad_perm:[2,3,0,1] row_mask:0xf bank_mask:0xf
    s_nop 1
    v_add_f32_dpp v16, v16, v16 row_half_mirror row_mask:0xf bank_mask:0xf
    s_nop 1
    v_add_f32_dpp v16, v16, v16 row_mirror row_mask:0xf bank_mask:0xf
    s_nop 1
    v_add_f32_dpp v16, v16, v16 row_bcast:15 row_mask:0xa bank_mask:0xf
    s_nop 1
    v_add_f32_dpp v16, v16, v16 row_bcast:31 row_mask:0xc bank_mask:0xf
    s_nop 0
    v_readlane_b32 s11, v16, 63
    v_mov_b32 v17, 0x3acccccd
    s_nop 0
    v_mul_f32 v16, s11, v17
    v_sub_f32 v18, v124, v16
    v_mul_f32 v19, v18, v18
    v_sub_f32 v18, v125, v16
    v_fmac_f32 v19, v18, v18
    v_sub_f32 v18, v126, v16
    v_fmac_f32 v19, v18, v18
    v_sub_f32 v18, v127, v16
    v_fmac_f32 v19, v18, v18
    v_sub_f32 v18, v128, v16
    v_fmac_f32 v19, v18, v18
    v_sub_f32 v18, v129, v16
    v_fmac_f32 v19, v18, v18
    v_sub_f32 v18, v130, v16
    v_fmac_f32 v19, v18, v18
    v_sub_f32 v18, v131, v16
    v_fmac_f32 v19, v18, v18
    v_sub_f32 v18, v132, v16
    v_fmac_f32 v19, v18, v18
    v_sub_f32 v18, v133, v16
    v_fmac_f32 v19, v18, v18
    s_nop 1
    v_add_f32_dpp v19, v19, v19 quad_perm:[1,0,3,2] row_mask:0xf bank_mask:0xf
    s_nop 1
    v_add_f32_dpp v19, v19, v19 quad_perm:[2,3,0,1] row_mask:0xf bank_mask:0xf
    s_nop 1
    v_add_f32_dpp v19, v19, v19 row_half_mirror row_mask:0xf bank_mask:0xf
    s_nop 1
    v_add_f32_dpp v19, v19, v19 row_mirror row_mask:0xf bank_mask:0xf
    s_nop 1
    v_add_f32_dpp v19, v19, v19 row_bcast:15 row_mask:0xa bank_mask:0xf
    s_nop 1
    v_add_f32_dpp v19, v19, v19 row_bcast:31 row_mask:0xc bank_mask:0xf
    s_nop 0
    v_readlane_b32 s11, v19, 63
    s_nop 1
    v_mul_f32 v19, s11, v17
    v_cvt_pk_bf16_f32 v19, v19, v16
    v_and_b32 v16, s95, v19
    v_lshlrev_b32 v19, 16, v19
    v_add_f32 v19, 0x3727c5ac, v19
    v_cvt_pk_bf16_f32 v19, v19, v19
    v_lshlrev_b32 v19, 16, v19
    v_sqrt_f32 v19, v19
    s_nop 0
    v_cvt_pk_bf16_f32 v19, v19, v19
    v_lshlrev_b32 v19, 16, v19
    v_rcp_f32 v20, v19
    s_mul_i32 s10, s10, 1280
    v_lshlrev_b32 v12, 2, v1
    v_add_u32 v12, s10, v12
    v_sub_f32 v124, v124, v16
    v_sub_f32 v125, v125, v16
    v_cvt_pk_bf16_f32 v17, v124, v125
    v_lshlrev_b32 v124, 16, v17
    v_and_b32 v125, s95, v17
    v_mul_f32 v17, v124, v20
    v_mul_f32 v18, v125, v20
    v_fma_f32 v124, -v17, v19, v124
    v_fma_f32 v125, -v18, v19, v125
    v_fmac_f32 v17, v124, v20
    v_fmac_f32 v18, v125, v20
    v_cvt_pk_bf16_f32 v17, v17, v18
    ds_write_b32 v12, v17 offset:0
    v_sub_f32 v126, v126, v16
    v_sub_f32 v127, v127, v16
    v_cvt_pk_bf16_f32 v17, v126, v127
    v_lshlrev_b32 v126, 16, v17
    v_and_b32 v127, s95, v17
    v_mul_f32 v17, v126, v20
    v_mul_f32 v18, v127, v20
    v_fma_f32 v126, -v17, v19, v126
    v_fma_f32 v127, -v18, v19, v127
    v_fmac_f32 v17, v126, v20
    v_fmac_f32 v18, v127, v20
    v_cvt_pk_bf16_f32 v17, v17, v18
    ds_write_b32 v12, v17 offset:256
    v_sub_f32 v128, v128, v16
    v_sub_f32 v129, v129, v16
    v_cvt_pk_bf16_f32 v17, v128, v129
    v_lshlrev_b32 v128, 16, v17
    v_and_b32 v129, s95, v17
    v_mul_f32 v17, v128, v20
    v_mul_f32 v18, v129, v20
    v_fma_f32 v128, -v17, v19, v128
    v_fma_f32 v129, -v18, v19, v129
    v_fmac_f32 v17, v128, v20
    v_fmac_f32 v18, v129, v20
    v_cvt_pk_bf16_f32 v17, v17, v18
    ds_write_b32 v12, v17 offset:512
    v_sub_f32 v130, v130, v16
    v_sub_f32 v131, v131, v16
    v_cvt_pk_bf16_f32 v17, v130, v131
    v_lshlrev_b32 v130, 16, v17
    v_and_b32 v131, s95, v17
    v_mul_f32 v17, v130, v20
    v_mul_f32 v18, v131, v20
    v_fma_f32 v130, -v17, v19, v130
    v_fma_f32 v131, -v18, v19, v131
    v_fmac_f32 v17, v130, v20
    v_fmac_f32 v18, v131, v20
    v_cvt_pk_bf16_f32 v17, v17, v18
    ds_write_b32 v12, v17 offset:768
    v_sub_f32 v132, v132, v16
    v_sub_f32 v133, v133, v16
    v_cvt_pk_bf16_f32 v17, v132, v133
    v_lshlrev_b32 v132, 16, v17
    v_and_b32 v133, s95, v17
    v_mul_f32 v17, v132, v20
    v_mul_f32 v18, v133, v20
    v_fma_f32 v132, -v17, v19, v132
    v_fma_f32 v133, -v18, v19, v133
    v_fmac_f32 v17, v132, v20
    v_fmac_f32 v18, v133, v20
    v_cvt_pk_bf16_f32 v17, v17, v18
    ds_write_b32 v12, v17 offset:1024
L_b1:
    s_waitcnt lgkmcnt(0)
    s_barrier
    s_mul_i32 s7, s14, 0x9E3779B1
    s_add_u32 s7, s7, 0x7F4A7C15
    s_mov_b32 s15, 400000
    s_cmp_lt_u32 s3, 5
    s_cbranch_scc0 L_pre
    v_bfe_u32 v9, v1, 3, 1
    v_lshrrev_b32 v10, 4, v1
    v_mul_u32_u24 v9, 1280, v9
    v_mul_u32_u24 v10, 40, v10
    s_mul_i32 s8, s5, 160
    v_add3_u32 v9, v9, v10, s8
    ds_read_b64 v[156:157], v9 offset:0
    ds_read_b64 v[158:159], v9 offset:8
    ds_read_b64 v[160:161], v9 offset:16
    ds_read_b64 v[162:163], v9 offset:24
    ds_read_b64 v[164:165], v9 offset:32
    s_waitcnt lgkmcnt(0)
    v_perm_b32 v10, v156, v156, s73
    v_perm_b32 v11, v161, v161, s73
    v_and_b32 v28, v10, v3
    v_and_b32 v29, v10, v4
    v_and_b32 v30, v10, v5
    v_and_b32 v31, v10, v6
    v_and_b32 v32, v11, v3
    v_and_b32 v33, v11, v4
    v_and_b32 v34, v11, v5
    v_and_b32 v35, v11, v6
    s_waitcnt vmcnt(9)
    v_mfma_f32_16x16x32_bf16 v[166:169], v[28:31], v[116:119], 0
    v_mfma_f32_16x16x32_bf16 v[170:173], v[32:35], v[116:119], 0
    v_perm_b32 v10, v156, v156, s74
    v_perm_b32 v11, v161, v161, s74
    v_and_b32 v28, v10, v3
    v_and_b32 v29, v10, v4
    v_and_b32 v30, v10, v5
    v_and_b32 v31, v10, v6
    v_and_b32 v32, v11, v3
    v_and_b32 v33, v11, v4
    v_and_b32 v34, v11, v5
    v_and_b32 v35, v11, v6
    s_waitcnt vmcnt(8)
    v_mfma_f32_16x16x32_bf16 v[166:169], v[28:31], v[120:123], v[166:169]
    v_mfma_f32_16x16x32_bf16 v[170:173], v[32:35], v[120:123], v[170:173]
    v_perm_b32 v10, v157, v157, s73
    v_perm_b32 v11, v162, v162, s73
    v_and_b32 v28, v10, v3
    v_and_b32 v29, v10, v4
    v_and_b32 v30, v10, v5
    v_and_b32 v31, v10, v6
    v_and_b32 v32, v11, v3
    v_and_b32 v33, v11, v4
    v_and_b32 v34, v11, v5
    v_and_b32 v35, v11, v6
    s_waitcnt vmcnt(7)
    v_mfma_f32_16x16x32_bf16 v[166:169], v[28:31], v[124:127], v[166:169]
    v_mfma_f32_16x16x32_bf16 v[170:173], v[32:35], v[124:127], v[170:173]
    v_perm_b32 v10, v157, v157, s74
    v_perm_b32 v11, v162, v162, s74
    v_and_b32 v28, v10, v3
    v_and_b32 v29, v10, v4
    v_and_b32 v30, v10, v5
    v_and_b32 v31, v10, v6
    v_and_b32 v32, v11, v3
    v_and_b32 v33, v11, v4
    v_and_b32 v34, v11, v5
    v_and_b32 v35, v11, v6
    s_waitcnt vmcnt(6)
    v_mfma_f32_16x16x32_bf16 v[166:169], v[28:31], v[128:131], v[166:169]
    v_mfma_f32_16x16x32_bf16 v[170:173], v[32:35], v[128:131], v[170:173]
    v_perm_b32 v10, v158, v158, s73
    v_perm_b32 v11, v163, v163, s73
    v_and_b32 v28, v10, v3
    v_and_b32 v29, v10, v4
    v_and_b32 v30, v10, v5
    v_and_b32 v31, v10, v6
    v_and_b32 v32, v11, v3
    v_and_b32 v33, v11, v4
    v_and_b32 v34, v11, v5
    v_and_b32 v35, v11, v6
    s_waitcnt vmcnt(5)
    v_mfma_f32_16x16x32_bf16 v[166:169], v[28:31], v[132:135], v[166:169]
    v_mfma_f32_16x16x32_bf16 v[170:173], v[32:35], v[132:135], v[170:173]
    v_perm_b32 v10, v158, v158, s74
    v_perm_b32 v11, v163, v163, s74
    v_and_b32 v28, v10, v3
    v_and_b32 v29, v10, v4
    v_and_b32 v30, v10, v5
    v_and_b32 v31, v10, v6
    v_and_b32 v32, v11, v3
    v_and_b32 v33, v11, v4
    v_and_b32 v34, v11, v5
    v_and_b32 v35, v11, v6
    s_waitcnt vmcnt(4)
    v_mfma_f32_16x16x32_bf16 v[166:169], v[28:31], v[136:139], v[166:169]
    v_mfma_f32_16x16x32_bf16 v[170:173], v[32:35], v[136:139], v[170:173]
    v_perm_b32 v10, v159, v159, s73
    v_perm_b32 v11, v164, v164, s73
    v_and_b32 v28, v10, v3
    v_and_b32 v29, v10, v4
    v_and_b32 v30, v10, v5
    v_and_b32 v31, v10, v6
    v_and_b32 v32, v11, v3
    v_and_b32 v33, v11, v4
    v_and_b32 v34, v11, v5
    v_and_b32 v35, v11, v6
    s_waitcnt vmcnt(3)
    v_mfma_f32_16x16x32_bf16 v[166:169], v[28:31], v[140:143], v[166:169]
    v_mfma_f32_16x16x32_bf16 v[170:173], v[32:35], v[140:143], v[170:173]
    v_perm_b32 v10, v159, v159, s74
    v_perm_b32 v11, v164, v164, s74
    v_and_b32 v28, v10, v3
    v_and_b32 v29, v10, v4
    v_and_b32 v30, v10, v5
    v_and_b32 v31, v10, v6
    v_and_b32 v32, v11, v3
    v_and_b32 v33, v11, v4
    v_and_b32 v34, v11, v5
    v_and_b32 v35, v11, v6
    s_waitcnt vmcnt(2)
    v_mfma_f32_16x16x32_bf16 v[166:169], v[28:31], v[144:147], v[166:169]
    v_mfma_f32_16x16x32_bf16 v[170:173], v[32:35], v[144:147], v[170:173]
    v_perm_b32 v10, v160, v160, s73
    v_perm_b32 v11, v165, v165, s73
    v_and_b32 v28, v10, v3
    v_and_b32 v29, v10, v4
    v_and_b32 v30, v10, v5
    v_and_b32 v31, v10, v6
    v_and_b32 v32, v11, v3
    v_and_b32 v33, v11, v4
    v_and_b32 v34, v11, v5
    v_and_b32 v35, v11, v6
    s_waitcnt vmcnt(1)
    v_mfma_f32_16x16x32_bf16 v[166:169], v[28:31], v[148:151], v[166:169]
    v_mfma_f32_16x16x32_bf16 v[170:173], v[32:35], v[148:151], v[170:173]
    v_perm_b32 v10, v160, v160, s74
    v_perm_b32 v11, v165, v165, s74
    v_and_b32 v28, v10, v3
    v_and_b32 v29, v10, v4
    v_and_b32 v30, v10, v5
    v_and_b32 v31, v10, v6
    v_and_b32 v32, v11, v3
    v_and_b32 v33, v11, v4
    v_and_b32 v34, v11, v5
    v_and_b32 v35, v11, v6
    s_waitcnt vmcnt(0)
    v_mfma_f32_16x16x32_bf16 v[166:169], v[28:31], v[152:155], v[166:169]
    v_mfma_f32_16x16x32_bf16 v[170:173], v[32:35], v[152:155], v[170:173]
    v_mov_b32 v13, s7
    v_mov_b32 v15, s7
    s_mul_i32 s8, s4, 3
    s_lshl_b32 s9, s4, 1
    s_add_u32 s9, s9, 93
    s_cmp_lt_u32 s3, 3
    s_cselect_b32 s8, s8, s9
    s_add_u32 s8, s8, s3
    s_lshl_b32 s8, s8, 13
    s_add_u32 s8, s8, 4096
    s_lshl_b32 s9, s5, 10
    s_add_u32 s9, s9, s8
    v_add_f32_dpp v12, v170, v166 row_ror:8 row_mask:0xf bank_mask:0x3
    v_add_f32_dpp v14, v171, v167 row_ror:8 row_mask:0xf bank_mask:0x3
    s_nop 0
    v_add_f32_dpp v12, v168, v172 row_ror:8 row_mask:0xf bank_mask:0xc
    v_add_f32_dpp v14, v169, v173 row_ror:8 row_mask:0xf bank_mask:0xc
    s_cmp_lt_u32 s3, 3
    s_cselect_b32 s10, 0, 0xc0c0c0c0
    s_mov_b32 exec_lo, s10
    s_mov_b32 exec_hi, s10
    v_mov_b32 v12, s100
    s_mov_b64 exec, -1
    buffer_store_dwordx4 v[12:15], v7, s[60:63], s9 offen sc1
    s_cmp_lt_u32 s3, 3
    s_cbranch_scc0 L_pre
    s_setprio 3
    v_lshrrev_b32 v9, 5, v1
    v_and_b32 v10, 31, v1
    v_lshlrev_b32 v9, 10, v9
    v_lshl_add_u32 v9, v10, 4, v9
    s_lshl_b32 s9, s6, 9
    s_add_u32 s8, s8, s9
    s_add_u32 s9, s8, 4096
    s_add_u32 s72, s85, 0
    s_sub_u32 s99, s72, 393216
    s_cselect_b32 s72, s72, s99
    buffer_load_dwordx4 v[176:179], v2, s[40:43], s72 offen nt
    buffer_load_dwordx4 v[180:183], v2, s[40:43], s72 offen offset:128 nt
    buffer_load_dwordx4 v[184:187], v2, s[40:43], s72 offen offset:256 nt
    s_waitcnt vmcnt(0)
    s_mov_b64 s[86:87], -1
    s_mov_b64 s[88:89], -1
    s_mov_b64 s[90:91], -1
    s_mov_b64 s[96:97], -1
L_gq:
    s_mov_b64 exec, s[86:87]
    s_cbranch_execz L_gqs0
    buffer_load_dwordx4 v[116:119], v9, s[60:63], s8 offen sc1
L_gqs0:
    s_mov_b64 exec, s[88:89]
    s_cbranch_execz L_gqs1
    buffer_load_dwordx4 v[120:123], v9, s[60:63], s8 offen offset:2048 sc1
L_gqs1:
    s_mov_b64 exec, s[90:91]
    s_cbranch_execz L_gqs2
    buffer_load_dwordx4 v[124:127], v9, s[60:63], s9 offen sc1
L_gqs2:
    s_mov_b64 exec, s[96:97]
    s_cbranch_execz L_gqs3
    buffer_load_dwordx4 v[128:131], v9, s[60:63], s9 offen offset:2048 sc1
L_gqs3:
    s_waitcnt vmcnt(0)
L_gqchk:
    s_mov_b64 exec, s[86:87]
    v_cmp_ne_u32 vcc, s7, v117
    v_cmp_ne_u32 s[86:87], s7, v119
    s_or_b64 s[86:87], s[86:87], vcc
    s_mov_b64 exec, s[88:89]
    v_cmp_ne_u32 vcc, s7, v121
    v_cmp_ne_u32 s[88:89], s7, v123
    s_or_b64 s[88:89], s[88:89], vcc
    s_mov_b64 exec, s[90:91]
    v_cmp_ne_u32 vcc, s7, v125
    v_cmp_ne_u32 s[90:91], s7, v127
    s_or_b64 s[90:91], s[90:91], vcc
    s_mov_b64 exec, s[96:97]
    v_cmp_ne_u32 vcc, s7, v129
    v_cmp_ne_u32 s[96:97], s7, v131
    s_or_b64 s[96:97], s[96:97], vcc
    s_or_b64 s[82:83], s[86:87], s[88:89]
    s_or_b64 s[82:83], s[82:83], s[90:91]
    s_or_b64 s[82:83], s[82:83], s[96:97]
    s_cmp_eq_u64 s[82:83], 0
    s_mov_b64 exec, -1
    s_cbranch_scc1 L_gq_ok
    s_sub_u32 s15, s15, 1
    s_cmp_lg_u32 s15, 0
    s_cbranch_scc1 L_gq
L_gq_ok:
    v_add_f32 v116, v116, v120
    v_add_f32 v124, v124, v128
    v_add_f32 v118, v118, v122
    v_add_f32 v126, v126, v130
    v_add_f32 v116, v116, v124
    v_add_f32 v118, v118, v126
    v_mov_b32 v117, v116
    v_mov_b32 v119, v118
    s_nop 0
    v_permlane32_swap_b32 v117, v116
    v_permlane32_swap_b32 v119, v118
    v_add_f32 v116, v116, v117
    v_add_f32 v118, v118, v119
    v_cvt_pk_bf16_f32 v116, v116, v118
    v_and_b32 v9, 7, v1
    v_lshlrev_b32 v9, 4, v9
    v_bfe_u32 v10, v1, 4, 1
    v_lshl_add_u32 v9, v10, 3, v9
    v_bfe_u32 v10, v1, 3, 1
    v_lshl_add_u32 v9, v10, 2, v9
    s_lshl_b32 s8, s3, 7
    v_add_u32 v9, s8, v9
    ds_write_b32 v9, v116 offset:2560
    v_mov_b32 v9, 0
    v_mov_b32 v10, 1
    s_mov_b64 exec, 1
    ds_add_u32 v9, v10 offset:3136
    s_mov_b64 exec, -1
    s_branch L_un1
L_pre:
    s_setprio 0
    s_cmp_eq_u32 s3, 7
    s_cbranch_scc1 L_un1
    s_cmp_lt_u32 s3, 5
    s_cbranch_scc1 L_un0
L_un0:
    s_add_u32 s72, s85, 0
    s_sub_u32 s99, s72, 393216
    s_cselect_b32 s72, s72, s99
    s_waitcnt vmcnt(2)
    buffer_load_dwordx4 v[176:179], v2, s[40:43], s72 offen nt
    s_waitcnt vmcnt(2)
    buffer_load_dwordx4 v[180:183], v2, s[40:43], s72 offen offset:128 nt
    s_waitcnt vmcnt(2)
    buffer_load_dwordx4 v[184:187], v2, s[40:43], s72 offen offset:256 nt
L_un1:
    s_add_u32 s72, s85, 24576
    s_sub_u32 s99, s72, 393216
    s_cselect_b32 s72, s72, s99
    s_waitcnt vmcnt(2)
    buffer_load_dwordx4 v[188:191], v2, s[40:43], s72 offen nt
    s_waitcnt vmcnt(2)
    buffer_load_dwordx4 v[192:195], v2, s[40:43], s72 offen offset:128 nt
    s_waitcnt vmcnt(2)
    buffer_load_dwordx4 v[196:199], v2, s[40:43], s72 offen offset:256 nt
L_un2:
    s_add_u32 s72, s85, 49152
    s_sub_u32 s99, s72, 393216
    s_cselect_b32 s72, s72, s99
    s_waitcnt vmcnt(2)
    buffer_load_dwordx4 v[200:203], v2, s[40:43], s72 offen nt
    s_waitcnt vmcnt(2)
    buffer_load_dwordx4 v[204:207], v2, s[40:43], s72 offen offset:128 nt
    s_waitcnt vmcnt(2)
    buffer_load_dwordx4 v[208:211], v2, s[40:43], s72 offen offset:256 nt
L_un3:
    s_add_u32 s72, s85, 73728
    s_sub_u32 s99, s72, 393216
    s_cselect_b32 s72, s72, s99
    s_waitcnt vmcnt(2)
    buffer_load_dwordx4 v[212:215], v2, s[40:43], s72 offen nt
    s_waitcnt vmcnt(2)
    buffer_load_dwordx4 v[216:219], v2, s[40:43], s72 offen offset:128 nt
    s_waitcnt vmcnt(2)
    buffer_load_dwordx4 v[220:223], v2, s[40:43], s72 offen offset:256 nt
L_un4:
    s_add_u32 s72, s85, 98304
    s_sub_u32 s99, s72, 393216
    s_cselect_b32 s72, s72, s99
    s_waitcnt vmcnt(2)
    buffer_load_dwordx4 v[224:227], v2, s[40:43], s72 offen nt
    s_waitcnt vmcnt(2)
    buffer_load_dwordx4 v[228:231], v2, s[40:43], s72 offen offset:128 nt
    s_waitcnt vmcnt(2)
    buffer_load_dwordx4 v[232:235], v2, s[40:43], s72 offen offset:256 nt
L_un5:
    s_add_u32 s72, s85, 122880
    s_sub_u32 s99, s72, 393216
    s_cselect_b32 s72, s72, s99
    s_waitcnt vmcnt(2)
    buffer_load_dwordx4 v[236:239], v2, s[40:43], s72 offen nt
    s_waitcnt vmcnt(2)
    buffer_load_dwordx4 v[240:243], v2, s[40:43], s72 offen offset:128 nt
    s_waitcnt vmcnt(2)
    buffer_load_dwordx4 v[244:247], v2, s[40:43], s72 offen offset:256 nt
L_un6:
    s_mov_b32 s8, 5120
    s_mov_b32 s82, 0x03ff03ff
    s_mov_b32 s83, 0x03ff03ff
    s_mov_b64 exec, s[82:83]
    s_waitcnt vmcnt(2)
    buffer_load_dwordx4 v[84:87], v248, s[52:55], 0 offen nt
    s_waitcnt vmcnt(2)
    buffer_load_dwordx4 v[88:91], v248, s[52:55], 0 offen offset:1280 nt
    s_waitcnt vmcnt(2)
    buffer_load_dwordx4 v[92:95], v248, s[52:55], 0 offen offset:2560 nt
    s_waitcnt vmcnt(2)
    buffer_load_dwordx4 v[96:99], v248, s[52:55], 0 offen offset:3840 nt
    s_waitcnt vmcnt(2)
    buffer_load_dwordx4 v[100:103], v248, s[52:55], s8 offen nt
    s_waitcnt vmcnt(2)
    buffer_load_dwordx4 v[104:107], v248, s[52:55], s8 offen offset:1280 nt
    s_cmp_lt_u32 s3, 6
    s_cbranch_scc0 L_nodn_p
    s_waitcnt vmcnt(2)
    buffer_load_dwordx4 v[108:111], v249, s[56:59], 0 offen nt
    s_waitcnt vmcnt(2)
    buffer_load_dwordx4 v[112:115], v249, s[56:59], 0 offen offset:1280 nt
L_nodn_p:
    s_mov_b64 exec, -1
    buffer_load_dword v27, v250, s[64:67], s84 offen
L_spinq:
    v_mov_b32 v9, 0
L_spinq2:
    ds_read_b32 v10, v9 offset:3136
    s_waitcnt lgkmcnt(0)
    v_readfirstlane_b32 s8, v10
    s_cmp_eq_u32 s8, 3
    s_cbranch_scc1 L_qok
    s_sub_u32 s15, s15, 1
    s_cmp_lg_u32 s15, 0
    s_cbranch_scc1 L_spinq2
L_qok:
    v_and_b32 v9, 7, v1
    v_lshlrev_b32 v9, 4, v9
    ds_read_b128 v[36:39], v9 offset:2560
    ds_read_b128 v[40:43], v9 offset:2688
    ds_read_b128 v[44:47], v9 offset:2816
    v_mov_b32 v24, 0xff7fffff
    v_mov_b32 v252, 0
    v_mov_b32 v255, 1
    s_waitcnt lgkmcnt(0)
    s_mov_b64 exec, 1
    ds_add_rtn_u32 v251, v252, v255 offset:3140
    s_mov_b64 exec, -1
    v_dot2_f32_bf16 v8, v176, v36, 0
    v_dot2_f32_bf16 v8, v177, v37, v8
    v_dot2_f32_bf16 v8, v178, v38, v8
    v_dot2_f32_bf16 v8, v179, v39, v8
    v_dot2_f32_bf16 v9, v180, v40, 0
    v_dot2_f32_bf16 v9, v181, v41, v9
    v_dot2_f32_bf16 v9, v182, v42, v9
    v_dot2_f32_bf16 v9, v183, v43, v9
    v_dot2_f32_bf16 v10, v184, v44, 0
    v_dot2_f32_bf16 v10, v185, v45, v10
    v_dot2_f32_bf16 v10, v186, v46, v10
    v_dot2_f32_bf16 v10, v187, v47, v10
    s_add_u32 s72, s85, 147456
    s_sub_u32 s99, s72, 393216
    s_cselect_b32 s72, s72, s99
    s_waitcnt lgkmcnt(0)
    v_readfirstlane_b32 s98, v251
    s_cmp_ge_u32 s98, 0
    s_cselect_b64 vcc, -1, 0
    s_cmp_gt_u32 s98, 7
    s_cbranch_scc1 L_w4_6_0
    s_cbranch_vccnz L_w3_6_0
    s_waitcnt vmcnt(1)
L_w3_6_0:
    s_waitcnt vmcnt(2)
L_w4_6_0:
    s_waitcnt vmcnt(3)
    buffer_load_dwordx4 v[176:179], v2, s[40:43], s72 offen nt
    s_cbranch_scc1 L_w4_6_1
    s_cbranch_vccnz L_w3_6_1
    s_waitcnt vmcnt(1)
L_w3_6_1:
    s_waitcnt vmcnt(2)
L_w4_6_1:
    s_waitcnt vmcnt(3)
    buffer_load_dwordx4 v[180:183], v2, s[40:43], s72 offen offset:128 nt
    s_cbranch_scc1 L_w4_6_2
    s_cbranch_vccnz L_w3_6_2
    s_waitcnt vmcnt(1)
L_w3_6_2:
    s_waitcnt vmcnt(2)
L_w4_6_2:
    s_waitcnt vmcnt(3)
    buffer_load_dwordx4 v[184:187], v2, s[40:43], s72 offen offset:256 nt
    v_add_f32 v8, v8, v9
    v_add_f32 v8, v8, v10
    s_nop 1
    v_add_f32_dpp v8, v8, v8 quad_perm:[1,0,3,2] row_mask:0xf bank_mask:0xf
    s_nop 1
    v_add_f32_dpp v8, v8, v8 quad_perm:[2,3,0,1] row_mask:0xf bank_mask:0xf
    s_nop 1
    v_add_f32_dpp v8, v8, v8 row_half_mirror row_mask:0xf bank_mask:0xf
    v_cvt_pk_bf16_f32 v8, v8, v8
    v_lshlrev_b32 v8, 16, v8
    v_mul_f32 v8, s75, v8
    v_cvt_pk_bf16_f32 v8, v8, v8
    v_and_b32 v48, s95, v8
    v_max_f32 v24, v24, v48
    s_mov_b64 exec, 1
    ds_add_rtn_u32 v251, v252, v255 offset:3140
    s_mov_b64 exec, -1
    v_dot2_f32_bf16 v8, v188, v36, 0
    v_dot2_f32_bf16 v8, v189, v37, v8
    v_dot2_f32_bf16 v8, v190, v38, v8
    v_dot2_f32_bf16 v8, v191, v39, v8
    v_dot2_f32_bf16 v9, v192, v40, 0
    v_dot2_f32_bf16 v9, v193, v41, v9
    v_dot2_f32_bf16 v9, v194, v42, v9
    v_dot2_f32_bf16 v9, v195, v43, v9
    v_dot2_f32_bf16 v10, v196, v44, 0
    v_dot2_f32_bf16 v10, v197, v45, v10
    v_dot2_f32_bf16 v10, v198, v46, v10
    v_dot2_f32_bf16 v10, v199, v47, v10
    s_add_u32 s72, s85, 172032
    s_sub_u32 s99, s72, 393216
    s_cselect_b32 s72, s72, s99
    s_waitcnt lgkmcnt(0)
    v_readfirstlane_b32 s98, v251
    s_cmp_ge_u32 s98, 8
    s_cselect_b64 vcc, -1, 0
    s_cmp_gt_u32 s98, 15
    s_cbranch_scc1 L_w4_7_0
    s_cbranch_vccnz L_w3_7_0
    s_waitcnt vmcnt(1)
L_w3_7_0:
    s_waitcnt vmcnt(2)
L_w4_7_0:
    s_waitcnt vmcnt(3)
    buffer_load_dwordx4 v[188:191], v2, s[40:43], s72 offen nt
    s_cbranch_scc1 L_w4_7_1
    s_cbranch_vccnz L_w3_7_1
    s_waitcnt vmcnt(1)
L_w3_7_1:
    s_waitcnt vmcnt(2)
L_w4_7_1:
    s_waitcnt vmcnt(3)
    buffer_load_dwordx4 v[192:195], v2, s[40:43], s72 offen offset:128 nt
    s_cbranch_scc1 L_w4_7_2
    s_cbranch_vccnz L_w3_7_2
    s_waitcnt vmcnt(1)
L_w3_7_2:
    s_waitcnt vmcnt(2)
L_w4_7_2:
    s_waitcnt vmcnt(3)
    buffer_load_dwordx4 v[196:199], v2, s[40:43], s72 offen offset:256 nt
    v_add_f32 v8, v8, v9
    v_add_f32 v8, v8, v10
    s_nop 1
    v_add_f32_dpp v8, v8, v8 quad_perm:[1,0,3,2] row_mask:0xf bank_mask:0xf
    s_nop 1
    v_add_f32_dpp v8, v8, v8 quad_perm:[2,3,0,1] row_mask:0xf bank_mask:0xf
    s_nop 1
    v_add_f32_dpp v8, v8, v8 row_half_mirror row_mask:0xf bank_mask:0xf
    v_cvt_pk_bf16_f32 v8, v8, v8
    v_lshlrev_b32 v8, 16, v8
    v_mul_f32 v8, s75, v8
    v_cvt_pk_bf16_f32 v8, v8, v8
    v_and_b32 v49, s95, v8
    v_max_f32 v24, v24, v49
    s_mov_b64 exec, 1
    ds_add_rtn_u32 v251, v252, v255 offset:3140
    s_mov_b64 exec, -1
    v_dot2_f32_bf16 v8, v200, v36, 0
    v_dot2_f32_bf16 v8, v201, v37, v8
    v_dot2_f32_bf16 v8, v202, v38, v8
    v_dot2_f32_bf16 v8, v203, v39, v8
    v_dot2_f32_bf16 v9, v204, v40, 0
    v_dot2_f32_bf16 v9, v205, v41, v9
    v_dot2_f32_bf16 v9, v206, v42, v9
    v_dot2_f32_bf16 v9, v207, v43, v9
    v_dot2_f32_bf16 v10, v208, v44, 0
    v_dot2_f32_bf16 v10, v209, v45, v10
    v_dot2_f32_bf16 v10, v210, v46, v10
    v_dot2_f32_bf16 v10, v211, v47, v10
    s_add_u32 s72, s85, 196608
    s_sub_u32 s99, s72, 393216
    s_cselect_b32 s72, s72, s99
    s_waitcnt lgkmcnt(0)
    v_readfirstlane_b32 s98, v251
    s_cmp_ge_u32 s98, 16
    s_cselect_b64 vcc, -1, 0
    s_cmp_gt_u32 s98, 23
    s_cbranch_scc1 L_w4_8_0
    s_cbranch_vccnz L_w3_8_0
    s_waitcnt vmcnt(1)
L_w3_8_0:
    s_waitcnt vmcnt(2)
L_w4_8_0:
    s_waitcnt vmcnt(3)
    buffer_load_dwordx4 v[200:203], v2, s[40:43], s72 offen nt
    s_cbranch_scc1 L_w4_8_1
    s_cbranch_vccnz L_w3_8_1
    s_waitcnt vmcnt(1)
L_w3_8_1:
    s_waitcnt vmcnt(2)
L_w4_8_1:
    s_waitcnt vmcnt(3)
    buffer_load_dwordx4 v[204:207], v2, s[40:43], s72 offen offset:128 nt
    s_cbranch_scc1 L_w4_8_2
    s_cbranch_vccnz L_w3_8_2
    s_waitcnt vmcnt(1)
L_w3_8_2:
    s_waitcnt vmcnt(2)
L_w4_8_2:
    s_waitcnt vmcnt(3)
    buffer_load_dwordx4 v[208:211], v2, s[40:43], s72 offen offset:256 nt
    v_add_f32 v8, v8, v9
    v_add_f32 v8, v8, v10
    s_nop 1
    v_add_f32_dpp v8, v8, v8 quad_perm:[1,0,3,2] row_mask:0xf bank_mask:0xf
    s_nop 1
    v_add_f32_dpp v8, v8, v8 quad_perm:[2,3,0,1] row_mask:0xf bank_mask:0xf
    s_nop 1
    v_add_f32_dpp v8, v8, v8 row_half_mirror row_mask:0xf bank_mask:0xf
    v_cvt_pk_bf16_f32 v8, v8, v8
    v_lshlrev_b32 v8, 16, v8
    v_mul_f32 v8, s75, v8
    v_cvt_pk_bf16_f32 v8, v8, v8
    v_and_b32 v50, s95, v8
    v_max_f32 v24, v24, v50
    s_mov_b64 exec, 1
    ds_add_rtn_u32 v251, v252, v255 offset:3140
    s_mov_b64 exec, -1
    v_dot2_f32_bf16 v8, v212, v36, 0
    v_dot2_f32_bf16 v8, v213, v37, v8
    v_dot2_f32_bf16 v8, v214, v38, v8
    v_dot2_f32_bf16 v8, v215, v39, v8
    v_dot2_f32_bf16 v9, v216, v40, 0
    v_dot2_f32_bf16 v9, v217, v41, v9
    v_dot2_f32_bf16 v9, v218, v42, v9
    v_dot2_f32_bf16 v9, v219, v43, v9
    v_dot2_f32_bf16 v10, v220, v44, 0
    v_dot2_f32_bf16 v10, v221, v45, v10
    v_dot2_f32_bf16 v10, v222, v46, v10
    v_dot2_f32_bf16 v10, v223, v47, v10
    s_add_u32 s72, s85, 221184
    s_sub_u32 s99, s72, 393216
    s_cselect_b32 s72, s72, s99
    s_waitcnt lgkmcnt(0)
    v_readfirstlane_b32 s98, v251
    s_cmp_ge_u32 s98, 24
    s_cselect_b64 vcc, -1, 0
    s_cmp_gt_u32 s98, 31
    s_cbranch_scc1 L_w4_9_0
    s_cbranch_vccnz L_w3_9_0
    s_waitcnt vmcnt(1)
L_w3_9_0:
    s_waitcnt vmcnt(2)
L_w4_9_0:
    s_waitcnt vmcnt(3)
    buffer_load_dwordx4 v[212:215], v2, s[40:43], s72 offen nt
    s_cbranch_scc1 L_w4_9_1
    s_cbranch_vccnz L_w3_9_1
    s_waitcnt vmcnt(1)
L_w3_9_1:
    s_waitcnt vmcnt(2)
L_w4_9_1:
    s_waitcnt vmcnt(3)
    buffer_load_dwordx4 v[216:219], v2, s[40:43], s72 offen offset:128 nt
    s_cbranch_scc1 L_w4_9_2
    s_cbranch_vccnz L_w3_9_2
    s_waitcnt vmcnt(1)
L_w3_9_2:
    s_waitcnt vmcnt(2)
L_w4_9_2:
    s_waitcnt vmcnt(3)
    buffer_load_dwordx4 v[220:223], v2, s[40:43], s72 offen offset:256 nt
    v_add_f32 v8, v8, v9
    v_add_f32 v8, v8, v10
    s_nop 1
    v_add_f32_dpp v8, v8, v8 quad_perm:[1,0,3,2] row_mask:0xf bank_mask:0xf
    s_nop 1
    v_add_f32_dpp v8, v8, v8 quad_perm:[2,3,0,1] row_mask:0xf bank_mask:0xf
    s_nop 1
    v_add_f32_dpp v8, v8, v8 row_half_mirror row_mask:0xf bank_mask:0xf
    v_cvt_pk_bf16_f32 v8, v8, v8
    v_lshlrev_b32 v8, 16, v8
    v_mul_f32 v8, s75, v8
    v_cvt_pk_bf16_f32 v8, v8, v8
    v_and_b32 v51, s95, v8
    v_max_f32 v24, v24, v51
    s_mov_b64 exec, 1
    ds_add_rtn_u32 v251, v252, v255 offset:3140
    s_mov_b64 exec, -1
    v_dot2_f32_bf16 v8, v224, v36, 0
    v_dot2_f32_bf16 v8, v225, v37, v8
    v_dot2_f32_bf16 v8, v226, v38, v8
    v_dot2_f32_bf16 v8, v227, v39, v8
    v_dot2_f32_bf16 v9, v228, v40, 0
    v_dot2_f32_bf16 v9, v229, v41, v9
    v_dot2_f32_bf16 v9, v230, v42, v9
    v_dot2_f32_bf16 v9, v231, v43, v9
    v_dot2_f32_bf16 v10, v232, v44, 0
    v_dot2_f32_bf16 v10, v233, v45, v10
    v_dot2_f32_bf16 v10, v234, v46, v10
    v_dot2_f32_bf16 v10, v235, v47, v10
    s_add_u32 s72, s85, 245760
    s_sub_u32 s99, s72, 393216
    s_cselect_b32 s72, s72, s99
    s_waitcnt lgkmcnt(0)
    v_readfirstlane_b32 s98, v251
    s_cmp_ge_u32 s98, 32
    s_cselect_b64 vcc, -1, 0
    s_cmp_gt_u32 s98, 39
    s_cbranch_scc1 L_w4_10_0
    s_cbranch_vccnz L_w3_10_0
    s_waitcnt vmcnt(1)
L_w3_10_0:
    s_waitcnt vmcnt(2)
L_w4_10_0:
    s_waitcnt vmcnt(3)
    buffer_load_dwordx4 v[224:227], v2, s[40:43], s72 offen nt
    s_cbranch_scc1 L_w4_10_1
    s_cbranch_vccnz L_w3_10_1
    s_waitcnt vmcnt(1)
L_w3_10_1:
    s_waitcnt vmcnt(2)
L_w4_10_1:
    s_waitcnt vmcnt(3)
    buffer_load_dwordx4 v[228:231], v2, s[40:43], s72 offen offset:128 nt
    s_cbranch_scc1 L_w4_10_2
    s_cbranch_vccnz L_w3_10_2
    s_waitcnt vmcnt(1)
L_w3_10_2:
    s_waitcnt vmcnt(2)
L_w4_10_2:
    s_waitcnt vmcnt(3)
    buffer_load_dwordx4 v[232:235], v2, s[40:43], s72 offen offset:256 nt
    v_add_f32 v8, v8, v9
    v_add_f32 v8, v8, v10
    s_nop 1
    v_add_f32_dpp v8, v8, v8 quad_perm:[1,0,3,2] row_mask:0xf bank_mask:0xf
    s_nop 1
    v_add_f32_dpp v8, v8, v8 quad_perm:[2,3,0,1] row_mask:0xf bank_mask:0xf
    s_nop 1
    v_add_f32_dpp v8, v8, v8 row_half_mirror row_mask:0xf bank_mask:0xf
    v_cvt_pk_bf16_f32 v8, v8, v8
    v_lshlrev_b32 v8, 16, v8
    v_mul_f32 v8, s75, v8
    v_cvt_pk_bf16_f32 v8, v8, v8
    v_and_b32 v52, s95, v8
    v_max_f32 v24, v24, v52
    s_mov_b64 exec, 1
    ds_add_rtn_u32 v251, v252, v255 offset:3140
    s_mov_b64 exec, -1
    v_dot2_f32_bf16 v8, v236, v36, 0
    v_dot2_f32_bf16 v8, v237, v37, v8
    v_dot2_f32_bf16 v8, v238, v38, v8
    v_dot2_f32_bf16 v8, v239, v39, v8
    v_dot2_f32_bf16 v9, v240, v40, 0
    v_dot2_f32_bf16 v9, v241, v41, v9
    v_dot2_f32_bf16 v9, v242, v42, v9
    v_dot2_f32_bf16 v9, v243, v43, v9
    v_dot2_f32_bf16 v10, v244, v44, 0
    v_dot2_f32_bf16 v10, v245, v45, v10
    v_dot2_f32_bf16 v10, v246, v46, v10
    v_dot2_f32_bf16 v10, v247, v47, v10
    s_add_u32 s72, s85, 270336
    s_sub_u32 s99, s72, 393216
    s_cselect_b32 s72, s72, s99
    s_waitcnt lgkmcnt(0)
    v_readfirstlane_b32 s98, v251
    s_cmp_ge_u32 s98, 40
    s_cselect_b64 vcc, -1, 0
    s_cmp_gt_u32 s98, 47
    s_cbranch_scc1 L_w4_11_0
    s_cbranch_vccnz L_w3_11_0
    s_waitcnt vmcnt(1)
L_w3_11_0:
    s_waitcnt vmcnt(2)
L_w4_11_0:
    s_waitcnt vmcnt(3)
    buffer_load_dwordx4 v[236:239], v2, s[40:43], s72 offen nt
    s_cbranch_scc1 L_w4_11_1
    s_cbranch_vccnz L_w3_11_1
    s_waitcnt vmcnt(1)
L_w3_11_1:
    s_waitcnt vmcnt(2)
L_w4_11_1:
    s_waitcnt vmcnt(3)
    buffer_load_dwordx4 v[240:243], v2, s[40:43], s72 offen offset:128 nt
    s_cbranch_scc1 L_w4_11_2
    s_cbranch_vccnz L_w3_11_2
    s_waitcnt vmcnt(1)
L_w3_11_2:
    s_waitcnt vmcnt(2)
L_w4_11_2:
    s_waitcnt vmcnt(3)
    buffer_load_dwordx4 v[244:247], v2, s[40:43], s72 offen offset:256 nt
    v_add_f32 v8, v8, v9
    v_add_f32 v8, v8, v10
    s_nop 1
    v_add_f32_dpp v8, v8, v8 quad_perm:[1,0,3,2] row_mask:0xf bank_mask:0xf
    s_nop 1
    v_add_f32_dpp v8, v8, v8 quad_perm:[2,3,0,1] row_mask:0xf bank_mask:0xf
    s_nop 1
    v_add_f32_dpp v8, v8, v8 row_half_mirror row_mask:0xf bank_mask:0xf
    v_cvt_pk_bf16_f32 v8, v8, v8
    v_lshlrev_b32 v8, 16, v8
    v_mul_f32 v8, s75, v8
    v_cvt_pk_bf16_f32 v8, v8, v8
    v_and_b32 v53, s95, v8
    v_max_f32 v24, v24, v53
    s_mov_b64 exec, 1
    ds_add_rtn_u32 v251, v252, v255 offset:3140
    s_mov_b64 exec, -1
    v_dot2_f32_bf16 v8, v176, v36, 0
    v_dot2_f32_bf16 v8, v177, v37, v8
    v_dot2_f32_bf16 v8, v178, v38, v8
    v_dot2_f32_bf16 v8, v179, v39, v8
    v_dot2_f32_bf16 v9, v180, v40, 0
    v_dot2_f32_bf16 v9, v181, v41, v9
    v_dot2_f32_bf16 v9, v182, v42, v9
    v_dot2_f32_bf16 v9, v183, v43, v9
    v_dot2_f32_bf16 v10, v184, v44, 0
    v_dot2_f32_bf16 v10, v185, v45, v10
    v_dot2_f32_bf16 v10, v186, v46, v10
    v_dot2_f32_bf16 v10, v187, v47, v10
    s_add_u32 s72, s85, 294912
    s_sub_u32 s99, s72, 393216
    s_cselect_b32 s72, s72, s99
    s_waitcnt lgkmcnt(0)
    v_readfirstlane_b32 s98, v251
    s_cmp_ge_u32 s98, 48
    s_cselect_b64 vcc, -1, 0
    s_cmp_gt_u32 s98, 55
    s_cbranch_scc1 L_w4_12_0
    s_cbranch_vccnz L_w3_12_0
    s_waitcnt vmcnt(1)
L_w3_12_0:
    s_waitcnt vmcnt(2)
L_w4_12_0:
    s_waitcnt vmcnt(3)
    buffer_load_dwordx4 v[176:179], v2, s[40:43], s72 offen nt
    s_cbranch_scc1 L_w4_12_1
    s_cbranch_vccnz L_w3_12_1
    s_waitcnt vmcnt(1)
L_w3_12_1:
    s_waitcnt vmcnt(2)
L_w4_12_1:
    s_waitcnt vmcnt(3)
    buffer_load_dwordx4 v[180:183], v2, s[40:43], s72 offen offset:128 nt
    s_cbranch_scc1 L_w4_12_2
    s_cbranch_vccnz L_w3_12_2
    s_waitcnt vmcnt(1)
L_w3_12_2:
    s_waitcnt vmcnt(2)
L_w4_12_2:
    s_waitcnt vmcnt(3)
    buffer_load_dwordx4 v[184:187], v2, s[40:43], s72 offen offset:256 nt
    v_add_f32 v8, v8, v9
    v_add_f32 v8, v8, v10
    s_nop 1
    v_add_f32_dpp v8, v8, v8 quad_perm:[1,0,3,2] row_mask:0xf bank_mask:0xf
    s_nop 1
    v_add_f32_dpp v8, v8, v8 quad_perm:[2,3,0,1] row_mask:0xf bank_mask:0xf
    s_nop 1
    v_add_f32_dpp v8, v8, v8 row_half_mirror row_mask:0xf bank_mask:0xf
    v_cvt_pk_bf16_f32 v8, v8, v8
    v_lshlrev_b32 v8, 16, v8
    v_mul_f32 v8, s75, v8
    v_cvt_pk_bf16_f32 v8, v8, v8
    v_and_b32 v54, s95, v8
    v_max_f32 v24, v24, v54
    s_mov_b64 exec, 1
    ds_add_rtn_u32 v251, v252, v255 offset:3140
    s_mov_b64 exec, -1
    v_dot2_f32_bf16 v8, v188, v36, 0
    v_dot2_f32_bf16 v8, v189, v37, v8
    v_dot2_f32_bf16 v8, v190, v38, v8
    v_dot2_f32_bf16 v8, v191, v39, v8
    v_dot2_f32_bf16 v9, v192, v40, 0
    v_dot2_f32_bf16 v9, v193, v41, v9
    v_dot2_f32_bf16 v9, v194, v42, v9
    v_dot2_f32_bf16 v9, v195, v43, v9
    v_dot2_f32_bf16 v10, v196, v44, 0
    v_dot2_f32_bf16 v10, v197, v45, v10
    v_dot2_f32_bf16 v10, v198, v46, v10
    v_dot2_f32_bf16 v10, v199, v47, v10
    s_add_u32 s72, s85, 319488
    s_sub_u32 s99, s72, 393216
    s_cselect_b32 s72, s72, s99
    s_waitcnt lgkmcnt(0)
    v_readfirstlane_b32 s98, v251
    s_cmp_ge_u32 s98, 56
    s_cselect_b64 vcc, -1, 0
    s_cmp_gt_u32 s98, 63
    s_cbranch_scc1 L_w4_13_0
    s_cbranch_vccnz L_w3_13_0
    s_waitcnt vmcnt(1)
L_w3_13_0:
    s_waitcnt vmcnt(2)
L_w4_13_0:
    s_waitcnt vmcnt(3)
    buffer_load_dwordx4 v[188:191], v2, s[40:43], s72 offen nt
    s_cbranch_scc1 L_w4_13_1
    s_cbranch_vccnz L_w3_13_1
    s_waitcnt vmcnt(1)
L_w3_13_1:
    s_waitcnt vmcnt(2)
L_w4_13_1:
    s_waitcnt vmcnt(3)
    buffer_load_dwordx4 v[192:195], v2, s[40:43], s72 offen offset:128 nt
    s_cbranch_scc1 L_w4_13_2
    s_cbranch_vccnz L_w3_13_2
    s_waitcnt vmcnt(1)
L_w3_13_2:
    s_waitcnt vmcnt(2)
L_w4_13_2:
    s_waitcnt vmcnt(3)
    buffer_load_dwordx4 v[196:199], v2, s[40:43], s72 offen offset:256 nt
    v_add_f32 v8, v8, v9
    v_add_f32 v8, v8, v10
    s_nop 1
    v_add_f32_dpp v8, v8, v8 quad_perm:[1,0,3,2] row_mask:0xf bank_mask:0xf
    s_nop 1
    v_add_f32_dpp v8, v8, v8 quad_perm:[2,3,0,1] row_mask:0xf bank_mask:0xf
    s_nop 1
    v_add_f32_dpp v8, v8, v8 row_half_mirror row_mask:0xf bank_mask:0xf
    v_cvt_pk_bf16_f32 v8, v8, v8
    v_lshlrev_b32 v8, 16, v8
    v_mul_f32 v8, s75, v8
    v_cvt_pk_bf16_f32 v8, v8, v8
    v_and_b32 v55, s95, v8
    v_max_f32 v24, v24, v55
    s_mov_b64 exec, 1
    ds_add_rtn_u32 v251, v252, v255 offset:3140
    s_mov_b64 exec, -1
    v_dot2_f32_bf16 v8, v200, v36, 0
    v_dot2_f32_bf16 v8, v201, v37, v8
    v_dot2_f32_bf16 v8, v202, v38, v8
    v_dot2_f32_bf16 v8, v203, v39, v8
    v_dot2_f32_bf16 v9, v204, v40, 0
    v_dot2_f32_bf16 v9, v205, v41, v9
    v_dot2_f32_bf16 v9, v206, v42, v9
    v_dot2_f32_bf16 v9, v207, v43, v9
    v_dot2_f32_bf16 v10, v208, v44, 0
    v_dot2_f32_bf16 v10, v209, v45, v10
    v_dot2_f32_bf16 v10, v210, v46, v10
    v_dot2_f32_bf16 v10, v211, v47, v10
    s_add_u32 s72, s85, 344064
    s_sub_u32 s99, s72, 393216
    s_cselect_b32 s72, s72, s99
    s_waitcnt lgkmcnt(0)
    v_readfirstlane_b32 s98, v251
    s_cmp_ge_u32 s98, 64
    s_cselect_b64 vcc, -1, 0
    s_cmp_gt_u32 s98, 71
    s_cbranch_scc1 L_w4_14_0
    s_cbranch_vccnz L_w3_14_0
    s_waitcnt vmcnt(1)
L_w3_14_0:
    s_waitcnt vmcnt(2)
L_w4_14_0:
    s_waitcnt vmcnt(3)
    buffer_load_dwordx4 v[200:203], v2, s[40:43], s72 offen nt
    s_cbranch_scc1 L_w4_14_1
    s_cbranch_vccnz L_w3_14_1
    s_waitcnt vmcnt(1)
L_w3_14_1:
    s_waitcnt vmcnt(2)
L_w4_14_1:
    s_waitcnt vmcnt(3)
    buffer_load_dwordx4 v[204:207], v2, s[40:43], s72 offen offset:128 nt
    s_cbranch_scc1 L_w4_14_2
    s_cbranch_vccnz L_w3_14_2
    s_waitcnt vmcnt(1)
L_w3_14_2:
    s_waitcnt vmcnt(2)
L_w4_14_2:
    s_waitcnt vmcnt(3)
    buffer_load_dwordx4 v[208:211], v2, s[40:43], s72 offen offset:256 nt
    buffer_load_dwordx4 v[76:79], v7, s[60:63], s78 offen sc1
    buffer_load_dwordx4 v[80:83], v7, s[60:63], s79 offen sc1
    v_add_f32 v8, v8, v9
    v_add_f32 v8, v8, v10
    s_nop 1
    v_add_f32_dpp v8, v8, v8 quad_perm:[1,0,3,2] row_mask:0xf bank_mask:0xf
    s_nop 1
    v_add_f32_dpp v8, v8, v8 quad_perm:[2,3,0,1] row_mask:0xf bank_mask:0xf
    s_nop 1
    v_add_f32_dpp v8, v8, v8 row_half_mirror row_mask:0xf bank_mask:0xf
    v_cvt_pk_bf16_f32 v8, v8, v8
    v_lshlrev_b32 v8, 16, v8
    v_mul_f32 v8, s75, v8
    v_cvt_pk_bf16_f32 v8, v8, v8
    v_and_b32 v56, s95, v8
    v_max_f32 v24, v24, v56
    s_mov_b64 exec, 1
    ds_add_rtn_u32 v251, v252, v255 offset:3140
    s_mov_b64 exec, -1
    v_dot2_f32_bf16 v8, v212, v36, 0
    v_dot2_f32_bf16 v8, v213, v37, v8
    v_dot2_f32_bf16 v8, v214, v38, v8
    v_dot2_f32_bf16 v8, v215, v39, v8
    v_dot2_f32_bf16 v9, v216, v40, 0
    v_dot2_f32_bf16 v9, v217, v41, v9
    v_dot2_f32_bf16 v9, v218, v42, v9
    v_dot2_f32_bf16 v9, v219, v43, v9
    v_dot2_f32_bf16 v10, v220, v44, 0
    v_dot2_f32_bf16 v10, v221, v45, v10
    v_dot2_f32_bf16 v10, v222, v46, v10
    v_dot2_f32_bf16 v10, v223, v47, v10
    s_add_u32 s72, s85, 368640
    s_sub_u32 s99, s72, 393216
    s_cselect_b32 s72, s72, s99
    s_waitcnt lgkmcnt(0)
    v_readfirstlane_b32 s98, v251
    s_cmp_ge_u32 s98, 72
    s_cselect_b64 vcc, -1, 0
    s_cmp_gt_u32 s98, 79
    s_cbranch_scc1 L_w4_15_0
    s_cbranch_vccnz L_w3_15_0
    s_waitcnt vmcnt(1)
L_w3_15_0:
    s_waitcnt vmcnt(2)
L_w4_15_0:
    s_waitcnt vmcnt(3)
    buffer_load_dwordx4 v[212:215], v2, s[40:43], s72 offen nt
    s_cbranch_scc1 L_w4_15_1
    s_cbranch_vccnz L_w3_15_1
    s_waitcnt vmcnt(1)
L_w3_15_1:
    s_waitcnt vmcnt(2)
L_w4_15_1:
    s_waitcnt vmcnt(3)
    buffer_load_dwordx4 v[216:219], v2, s[40:43], s72 offen offset:128 nt
    s_cbranch_scc1 L_w4_15_2
    s_cbranch_vccnz L_w3_15_2
    s_waitcnt vmcnt(1)
L_w3_15_2:
    s_waitcnt vmcnt(2)
L_w4_15_2:
    s_waitcnt vmcnt(3)
    buffer_load_dwordx4 v[220:223], v2, s[40:43], s72 offen offset:256 nt
    v_add_f32 v8, v8, v9
    v_add_f32 v8, v8, v10
    s_nop 1
    v_add_f32_dpp v8, v8, v8 quad_perm:[1,0,3,2] row_mask:0xf bank_mask:0xf
    s_nop 1
    v_add_f32_dpp v8, v8, v8 quad_perm:[2,3,0,1] row_mask:0xf bank_mask:0xf
    s_nop 1
    v_add_f32_dpp v8, v8, v8 row_half_mirror row_mask:0xf bank_mask:0xf
    v_cvt_pk_bf16_f32 v8, v8, v8
    v_lshlrev_b32 v8, 16, v8
    v_mul_f32 v8, s75, v8
    v_cvt_pk_bf16_f32 v8, v8, v8
    v_and_b32 v57, s95, v8
    v_max_f32 v24, v24, v57
    s_mov_b64 exec, 1
    ds_add_rtn_u32 v251, v252, v255 offset:3140
    s_mov_b64 exec, -1
    v_dot2_f32_bf16 v8, v224, v36, 0
    v_dot2_f32_bf16 v8, v225, v37, v8
    v_dot2_f32_bf16 v8, v226, v38, v8
    v_dot2_f32_bf16 v8, v227, v39, v8
    v_dot2_f32_bf16 v9, v228, v40, 0
    v_dot2_f32_bf16 v9, v229, v41, v9
    v_dot2_f32_bf16 v9, v230, v42, v9
    v_dot2_f32_bf16 v9, v231, v43, v9
    v_dot2_f32_bf16 v10, v232, v44, 0
    v_dot2_f32_bf16 v10, v233, v45, v10
    v_dot2_f32_bf16 v10, v234, v46, v10
    v_dot2_f32_bf16 v10, v235, v47, v10
    s_add_u32 s72, s85, 0
    s_sub_u32 s99, s72, 393216
    s_cselect_b32 s72, s72, s99
    s_waitcnt lgkmcnt(0)
    v_readfirstlane_b32 s98, v251
    s_cmp_ge_u32 s98, 80
    s_cselect_b64 vcc, -1, 0
    s_cmp_gt_u32 s98, 87
    s_cbranch_scc1 L_w4_16_0
    s_cbranch_vccnz L_w3_16_0
    s_waitcnt vmcnt(1)
L_w3_16_0:
    s_waitcnt vmcnt(2)
L_w4_16_0:
    s_waitcnt vmcnt(3)
    buffer_load_dwordx4 v[224:227], v2, s[44:47], s72 offen nt
    s_cbranch_scc1 L_w4_16_1
    s_cbranch_vccnz L_w3_16_1
    s_waitcnt vmcnt(1)
L_w3_16_1:
    s_waitcnt vmcnt(2)
L_w4_16_1:
    s_waitcnt vmcnt(3)
    buffer_load_dwordx4 v[228:231], v2, s[44:47], s72 offen offset:128 nt
    s_cbranch_scc1 L_w4_16_2
    s_cbranch_vccnz L_w3_16_2
    s_waitcnt vmcnt(1)
L_w3_16_2:
    s_waitcnt vmcnt(2)
L_w4_16_2:
    s_waitcnt vmcnt(3)
    buffer_load_dwordx4 v[232:235], v2, s[44:47], s72 offen offset:256 nt
    v_add_f32 v8, v8, v9
    v_add_f32 v8, v8, v10
    s_nop 1
    v_add_f32_dpp v8, v8, v8 quad_perm:[1,0,3,2] row_mask:0xf bank_mask:0xf
    s_nop 1
    v_add_f32_dpp v8, v8, v8 quad_perm:[2,3,0,1] row_mask:0xf bank_mask:0xf
    s_nop 1
    v_add_f32_dpp v8, v8, v8 row_half_mirror row_mask:0xf bank_mask:0xf
    v_cvt_pk_bf16_f32 v8, v8, v8
    v_lshlrev_b32 v8, 16, v8
    v_mul_f32 v8, s75, v8
    v_cvt_pk_bf16_f32 v8, v8, v8
    v_and_b32 v58, s95, v8
    v_max_f32 v24, v24, v58
    s_mov_b64 exec, 1
    ds_add_rtn_u32 v251, v252, v255 offset:3140
    s_mov_b64 exec, -1
    v_dot2_f32_bf16 v8, v236, v36, 0
    v_dot2_f32_bf16 v8, v237, v37, v8
    v_dot2_f32_bf16 v8, v238, v38, v8
    v_dot2_f32_bf16 v8, v239, v39, v8
    v_dot2_f32_bf16 v9, v240, v40, 0
    v_dot2_f32_bf16 v9, v241, v41, v9
    v_dot2_f32_bf16 v9, v242, v42, v9
    v_dot2_f32_bf16 v9, v243, v43, v9
    v_dot2_f32_bf16 v10, v244, v44, 0
    v_dot2_f32_bf16 v10, v245, v45, v10
    v_dot2_f32_bf16 v10, v246, v46, v10
    v_dot2_f32_bf16 v10, v247, v47, v10
    s_add_u32 s72, s85, 24576
    s_sub_u32 s99, s72, 393216
    s_cselect_b32 s72, s72, s99
    s_waitcnt lgkmcnt(0)
    v_readfirstlane_b32 s98, v251
    s_cmp_ge_u32 s98, 88
    s_cselect_b64 vcc, -1, 0
    s_cmp_gt_u32 s98, 95
    s_cbranch_scc1 L_w4_17_0
    s_cbranch_vccnz L_w3_17_0
    s_waitcnt vmcnt(1)
L_w3_17_0:
    s_waitcnt vmcnt(2)
L_w4_17_0:
    s_waitcnt vmcnt(3)
    buffer_load_dwordx4 v[236:239], v2, s[44:47], s72 offen nt
    s_cbranch_scc1 L_w4_17_1
    s_cbranch_vccnz L_w3_17_1
    s_waitcnt vmcnt(1)
L_w3_17_1:
    s_waitcnt vmcnt(2)
L_w4_17_1:
    s_waitcnt vmcnt(3)
    buffer_load_dwordx4 v[240:243], v2, s[44:47], s72 offen offset:128 nt
    s_cbranch_scc1 L_w4_17_2
    s_cbranch_vccnz L_w3_17_2
    s_waitcnt vmcnt(1)
L_w3_17_2:
    s_waitcnt vmcnt(2)
L_w4_17_2:
    s_waitcnt vmcnt(3)
    buffer_load_dwordx4 v[244:247], v2, s[44:47], s72 offen offset:256 nt
    v_add_f32 v8, v8, v9
    v_add_f32 v8, v8, v10
    s_nop 1
    v_add_f32_dpp v8, v8, v8 quad_perm:[1,0,3,2] row_mask:0xf bank_mask:0xf
    s_nop 1
    v_add_f32_dpp v8, v8, v8 quad_perm:[2,3,0,1] row_mask:0xf bank_mask:0xf
    s_nop 1
    v_add_f32_dpp v8, v8, v8 row_half_mirror row_mask:0xf bank_mask:0xf
    v_cvt_pk_bf16_f32 v8, v8, v8
    v_lshlrev_b32 v8, 16, v8
    v_mul_f32 v8, s75, v8
    v_cvt_pk_bf16_f32 v8, v8, v8
    v_and_b32 v59, s95, v8
    v_max_f32 v24, v24, v59
    s_mov_b64 exec, 1
    ds_add_rtn_u32 v251, v252, v255 offset:3140
    s_mov_b64 exec, -1
    v_dot2_f32_bf16 v8, v176, v36, 0
    v_dot2_f32_bf16 v8, v177, v37, v8
    v_dot2_f32_bf16 v8, v178, v38, v8
    v_dot2_f32_bf16 v8, v179, v39, v8
    v_dot2_f32_bf16 v9, v180, v40, 0
    v_dot2_f32_bf16 v9, v181, v41, v9
    v_dot2_f32_bf16 v9, v182, v42, v9
    v_dot2_f32_bf16 v9, v183, v43, v9
    v_dot2_f32_bf16 v10, v184, v44, 0
    v_dot2_f32_bf16 v10, v185, v45, v10
    v_dot2_f32_bf16 v10, v186, v46, v10
    v_dot2_f32_bf16 v10, v187, v47, v10
    s_add_u32 s72, s85, 49152
    s_sub_u32 s99, s72, 393216
    s_cselect_b32 s72, s72, s99
    s_waitcnt lgkmcnt(0)
    v_readfirstlane_b32 s98, v251
    s_cmp_ge_u32 s98, 96
    s_cselect_b64 vcc, -1, 0
    s_cmp_gt_u32 s98, 103
    s_cbranch_scc1 L_w4_18_0
    s_cbranch_vccnz L_w3_18_0
    s_waitcnt vmcnt(1)
L_w3_18_0:
    s_waitcnt vmcnt(2)
L_w4_18_0:
    s_waitcnt vmcnt(3)
    buffer_load_dwordx4 v[176:179], v2, s[44:47], s72 offen nt
    s_cbranch_scc1 L_w4_18_1
    s_cbranch_vccnz L_w3_18_1
    s_waitcnt vmcnt(1)
L_w3_18_1:
    s_waitcnt vmcnt(2)
L_w4_18_1:
    s_waitcnt vmcnt(3)
    buffer_load_dwordx4 v[180:183], v2, s[44:47], s72 offen offset:128 nt
    s_cbranch_scc1 L_w4_18_2
    s_cbranch_vccnz L_w3_18_2
    s_waitcnt vmcnt(1)
L_w3_18_2:
    s_waitcnt vmcnt(2)
L_w4_18_2:
    s_waitcnt vmcnt(3)
    buffer_load_dwordx4 v[184:187], v2, s[44:47], s72 offen offset:256 nt
    v_add_f32 v8, v8, v9
    v_add_f32 v8, v8, v10
    s_nop 1
    v_add_f32_dpp v8, v8, v8 quad_perm:[1,0,3,2] row_mask:0xf bank_mask:0xf
    s_nop 1
    v_add_f32_dpp v8, v8, v8 quad_perm:[2,3,0,1] row_mask:0xf bank_mask:0xf
    s_nop 1
    v_add_f32_dpp v8, v8, v8 row_half_mirror row_mask:0xf bank_mask:0xf
    v_cvt_pk_bf16_f32 v8, v8, v8
    v_lshlrev_b32 v8, 16, v8
    v_mul_f32 v8, s75, v8
    v_cvt_pk_bf16_f32 v8, v8, v8
    v_and_b32 v60, s95, v8
    v_max_f32 v24, v24, v60
    s_mov_b64 exec, 1
    ds_add_rtn_u32 v251, v252, v255 offset:3140
    s_mov_b64 exec, -1
    v_dot2_f32_bf16 v8, v188, v36, 0
    v_dot2_f32_bf16 v8, v189, v37, v8
    v_dot2_f32_bf16 v8, v190, v38, v8
    v_dot2_f32_bf16 v8, v191, v39, v8
    v_dot2_f32_bf16 v9, v192, v40, 0
    v_dot2_f32_bf16 v9, v193, v41, v9
    v_dot2_f32_bf16 v9, v194, v42, v9
    v_dot2_f32_bf16 v9, v195, v43, v9
    v_dot2_f32_bf16 v10, v196, v44, 0
    v_dot2_f32_bf16 v10, v197, v45, v10
    v_dot2_f32_bf16 v10, v198, v46, v10
    v_dot2_f32_bf16 v10, v199, v47, v10
    s_add_u32 s72, s85, 73728
    s_sub_u32 s99, s72, 393216
    s_cselect_b32 s72, s72, s99
    s_waitcnt lgkmcnt(0)
    v_readfirstlane_b32 s98, v251
    s_cmp_ge_u32 s98, 104
    s_cselect_b64 vcc, -1, 0
    s_cmp_gt_u32 s98, 111
    s_cbranch_scc1 L_w4_19_0
    s_cbranch_vccnz L_w3_19_0
    s_waitcnt vmcnt(1)
L_w3_19_0:
    s_waitcnt vmcnt(2)
L_w4_19_0:
    s_waitcnt vmcnt(3)
    buffer_load_dwordx4 v[188:191], v2, s[44:47], s72 offen nt
    s_cbranch_scc1 L_w4_19_1
    s_cbranch_vccnz L_w3_19_1
    s_waitcnt vmcnt(1)
L_w3_19_1:
    s_waitcnt vmcnt(2)
L_w4_19_1:
    s_waitcnt vmcnt(3)
    buffer_load_dwordx4 v[192:195], v2, s[44:47], s72 offen offset:128 nt
    s_cbranch_scc1 L_w4_19_2
    s_cbranch_vccnz L_w3_19_2
    s_waitcnt vmcnt(1)
L_w3_19_2:
    s_waitcnt vmcnt(2)
L_w4_19_2:
    s_waitcnt vmcnt(3)
    buffer_load_dwordx4 v[196:199], v2, s[44:47], s72 offen offset:256 nt
    v_add_f32 v8, v8, v9
    v_add_f32 v8, v8, v10
    s_nop 1
    v_add_f32_dpp v8, v8, v8 quad_perm:[1,0,3,2] row_mask:0xf bank_mask:0xf
    s_nop 1
    v_add_f32_dpp v8, v8, v8 quad_perm:[2,3,0,1] row_mask:0xf bank_mask:0xf
    s_nop 1
    v_add_f32_dpp v8, v8, v8 row_half_mirror row_mask:0xf bank_mask:0xf
    v_cvt_pk_bf16_f32 v8, v8, v8
    v_lshlrev_b32 v8, 16, v8
    v_mul_f32 v8, s75, v8
    v_cvt_pk_bf16_f32 v8, v8, v8
    v_and_b32 v61, s95, v8
    v_max_f32 v24, v24, v61
    s_mov_b64 exec, 1
    ds_add_rtn_u32 v251, v252, v255 offset:3140
    s_mov_b64 exec, -1
    v_dot2_f32_bf16 v8, v200, v36, 0
    v_dot2_f32_bf16 v8, v201, v37, v8
    v_dot2_f32_bf16 v8, v202, v38, v8
    v_dot2_f32_bf16 v8, v203, v39, v8
    v_dot2_f32_bf16 v9, v204, v40, 0
    v_dot2_f32_bf16 v9, v205, v41, v9
    v_dot2_f32_bf16 v9, v206, v42, v9
    v_dot2_f32_bf16 v9, v207, v43, v9
    v_dot2_f32_bf16 v10, v208, v44, 0
    v_dot2_f32_bf16 v10, v209, v45, v10
    v_dot2_f32_bf16 v10, v210, v46, v10
    v_dot2_f32_bf16 v10, v211, v47, v10
    s_add_u32 s72, s85, 98304
    s_sub_u32 s99, s72, 393216
    s_cselect_b32 s72, s72, s99
    s_waitcnt lgkmcnt(0)
    v_readfirstlane_b32 s98, v251
    s_cmp_ge_u32 s98, 112
    s_cselect_b64 vcc, -1, 0
    s_cmp_gt_u32 s98, 119
    s_cbranch_scc1 L_w4_20_0
    s_cbranch_vccnz L_w3_20_0
    s_waitcnt vmcnt(1)
L_w3_20_0:
    s_waitcnt vmcnt(2)
L_w4_20_0:
    s_waitcnt vmcnt(3)
    buffer_load_dwordx4 v[200:203], v2, s[44:47], s72 offen nt
    s_cbranch_scc1 L_w4_20_1
    s_cbranch_vccnz L_w3_20_1
    s_waitcnt vmcnt(1)
L_w3_20_1:
    s_waitcnt vmcnt(2)
L_w4_20_1:
    s_waitcnt vmcnt(3)
    buffer_load_dwordx4 v[204:207], v2, s[44:47], s72 offen offset:128 nt
    s_cbranch_scc1 L_w4_20_2
    s_cbranch_vccnz L_w3_20_2
    s_waitcnt vmcnt(1)
L_w3_20_2:
    s_waitcnt vmcnt(2)
L_w4_20_2:
    s_waitcnt vmcnt(3)
    buffer_load_dwordx4 v[208:211], v2, s[44:47], s72 offen offset:256 nt
    v_add_f32 v8, v8, v9
    v_add_f32 v8, v8, v10
    s_nop 1
    v_add_f32_dpp v8, v8, v8 quad_perm:[1,0,3,2] row_mask:0xf bank_mask:0xf
    s_nop 1
    v_add_f32_dpp v8, v8, v8 quad_perm:[2,3,0,1] row_mask:0xf bank_mask:0xf
    s_nop 1
    v_add_f32_dpp v8, v8, v8 row_half_mirror row_mask:0xf bank_mask:0xf
    v_cvt_pk_bf16_f32 v8, v8, v8
    v_lshlrev_b32 v8, 16, v8
    v_mul_f32 v8, s75, v8
    v_cvt_pk_bf16_f32 v8, v8, v8
    v_and_b32 v62, s95, v8
    v_max_f32 v24, v24, v62
    s_mov_b64 exec, 1
    ds_add_rtn_u32 v251, v252, v255 offset:3140
    s_mov_b64 exec, -1
    v_dot2_f32_bf16 v8, v212, v36, 0
    v_dot2_f32_bf16 v8, v213, v37, v8
    v_dot2_f32_bf16 v8, v214, v38, v8
    v_dot2_f32_bf16 v8, v215, v39, v8
    v_dot2_f32_bf16 v9, v216, v40, 0
    v_dot2_f32_bf16 v9, v217, v41, v9
    v_dot2_f32_bf16 v9, v218, v42, v9
    v_dot2_f32_bf16 v9, v219, v43, v9
    v_dot2_f32_bf16 v10, v220, v44, 0
    v_dot2_f32_bf16 v10, v221, v45, v10
    v_dot2_f32_bf16 v10, v222, v46, v10
    v_dot2_f32_bf16 v10, v223, v47, v10
    s_add_u32 s72, s85, 122880
    s_sub_u32 s99, s72, 393216
    s_cselect_b32 s72, s72, s99
    s_waitcnt lgkmcnt(0)
    v_readfirstlane_b32 s98, v251
    s_cmp_ge_u32 s98, 120
    s_cselect_b64 vcc, -1, 0
    s_cmp_gt_u32 s98, 127
    s_cbranch_scc1 L_w4_21_0
    s_cbranch_vccnz L_w3_21_0
    s_waitcnt vmcnt(1)
L_w3_21_0:
    s_waitcnt vmcnt(2)
L_w4_21_0:
    s_waitcnt vmcnt(3)
    buffer_load_dwordx4 v[212:215], v2, s[44:47], s72 offen nt
    s_cbranch_scc1 L_w4_21_1
    s_cbranch_vccnz L_w3_21_1
    s_waitcnt vmcnt(1)
L_w3_21_1:
    s_waitcnt vmcnt(2)
L_w4_21_1:
    s_waitcnt vmcnt(3)
    buffer_load_dwordx4 v[216:219], v2, s[44:47], s72 offen offset:128 nt
    s_cbranch_scc1 L_w4_21_2
    s_cbranch_vccnz L_w3_21_2
    s_waitcnt vmcnt(1)
L_w3_21_2:
    s_waitcnt vmcnt(2)
L_w4_21_2:
    s_waitcnt vmcnt(3)
    buffer_load_dwordx4 v[220:223], v2, s[44:47], s72 offen offset:256 nt
    v_add_f32 v8, v8, v9
    v_add_f32 v8, v8, v10
    s_nop 1
    v_add_f32_dpp v8, v8, v8 quad_perm:[1,0,3,2] row_mask:0xf bank_mask:0xf
    s_nop 1
    v_add_f32_dpp v8, v8, v8 quad_perm:[2,3,0,1] row_mask:0xf bank_mask:0xf
    s_nop 1
    v_add_f32_dpp v8, v8, v8 row_half_mirror row_mask:0xf bank_mask:0xf
    v_cvt_pk_bf16_f32 v8, v8, v8
    v_lshlrev_b32 v8, 16, v8
    v_mul_f32 v8, s75, v8
    v_cvt_pk_bf16_f32 v8, v8, v8
    v_and_b32 v63, s95, v8
    v_max_f32 v24, v24, v63
    s_nop 1
    v_max_f32_dpp v24, v24, v24 row_ror:8 row_mask:0xf bank_mask:0xf
    v_mov_b32 v8, v24
    s_nop 1
    v_permlane16_swap_b32 v8, v24
    v_max_f32 v24, v24, v8
    v_mov_b32 v8, v24
    s_nop 1
    v_permlane32_swap_b32 v8, v24
    v_max_f32 v24, v24, v8
    v_mul_f32 v12, s76, v24
    v_sub_f32 v12, 0, v12
    v_fma_f32 v48, v48, s76, v12
    v_fma_f32 v49, v49, s76, v12
    v_fma_f32 v50, v50, s76, v12
    v_fma_f32 v51, v51, s76, v12
    v_fma_f32 v52, v52, s76, v12
    v_fma_f32 v53, v53, s76, v12
    v_fma_f32 v54, v54, s76, v12
    v_fma_f32 v55, v55, s76, v12
    v_fma_f32 v56, v56, s76, v12
    v_fma_f32 v57, v57, s76, v12
    v_fma_f32 v58, v58, s76, v12
    v_fma_f32 v59, v59, s76, v12
    v_fma_f32 v60, v60, s76, v12
    v_fma_f32 v61, v61, s76, v12
    v_fma_f32 v62, v62, s76, v12
    v_fma_f32 v63, v63, s76, v12
    v_exp_f32 v48, v48
    v_exp_f32 v49, v49
    v_exp_f32 v50, v50
    v_exp_f32 v51, v51
    v_exp_f32 v52, v52
    v_exp_f32 v53, v53
    v_exp_f32 v54, v54
    v_exp_f32 v55, v55
    v_exp_f32 v56, v56
    v_exp_f32 v57, v57
    v_exp_f32 v58, v58
    v_exp_f32 v59, v59
    v_exp_f32 v60, v60
    v_exp_f32 v61, v61
    v_exp_f32 v62, v62
    v_exp_f32 v63, v63
    v_add_f32 v25, v48, v49
    v_add_f32 v25, v25, v50
    v_add_f32 v25, v25, v51
    v_add_f32 v25, v25, v52
    v_add_f32 v25, v25, v53
    v_add_f32 v25, v25, v54
    v_add_f32 v25, v25, v55
    v_add_f32 v25, v25, v56
    v_add_f32 v25, v25, v57
    v_add_f32 v25, v25, v58
    v_add_f32 v25, v25, v59
    v_add_f32 v25, v25, v60
    v_add_f32 v25, v25, v61
    v_add_f32 v25, v25, v62
    v_add_f32 v25, v25, v63
    v_cvt_pk_bf16_f32 v48, v48, v48
    v_cvt_pk_bf16_f32 v49, v49, v49
    v_cvt_pk_bf16_f32 v50, v50, v50
    v_cvt_pk_bf16_f32 v51, v51, v51
    v_cvt_pk_bf16_f32 v52, v52, v52
    v_cvt_pk_bf16_f32 v53, v53, v53
    v_cvt_pk_bf16_f32 v54, v54, v54
    v_cvt_pk_bf16_f32 v55, v55, v55
    v_cvt_pk_bf16_f32 v56, v56, v56
    v_cvt_pk_bf16_f32 v57, v57, v57
    v_cvt_pk_bf16_f32 v58, v58, v58
    v_cvt_pk_bf16_f32 v59, v59, v59
    v_cvt_pk_bf16_f32 v60, v60, v60
    v_cvt_pk_bf16_f32 v61, v61, v61
    v_cvt_pk_bf16_f32 v62, v62, v62
    v_cvt_pk_bf16_f32 v63, v63, v63
    v_add_f32_dpp v25, v25, v25 row_ror:8 row_mask:0xf bank_mask:0xf
    v_mov_b32 v8, v25
    s_nop 1
    v_permlane16_swap_b32 v8, v25
    v_add_f32 v25, v25, v8
    v_mov_b32 v8, v25
    s_nop 1
    v_permlane32_swap_b32 v8, v25
    v_add_f32 v25, v25, v8
    s_lshl_b32 s8, s3, 2
    v_mov_b32 v9, s8
    s_mov_b64 exec, 1
    ds_write_b32 v9, v24 offset:3072
    ds_write_b32 v9, v25 offset:3104
    s_mov_b64 exec, -1
    v_lshrrev_b32 v10, 5, v1
    s_lshl_b32 s8, s3, 1
    v_add_u32 v10, s8, v10
    v_mul_u32_u24 v26, 768, v10
    v_and_b32 v10, 7, v1
    v_lshl_add_u32 v26, v10, 5, v26
    v_bfe_u32 v10, v1, 4, 1
    v_lshl_add_u32 v26, v10, 4, v26
    s_mov_b64 exec, 1
    ds_add_rtn_u32 v251, v252, v255 offset:3140
    s_mov_b64 exec, -1
    v_and_b32 v28, v48, v3
    v_and_b32 v29, v48, v4
    v_and_b32 v30, v48, v5
    v_and_b32 v31, v48, v6
    s_nop 1
    v_mfma_f32_16x16x32_bf16 v[64:67], v[28:31], v[224:227], 0
    v_mfma_f32_16x16x32_bf16 v[68:71], v[28:31], v[228:231], 0
    v_mfma_f32_16x16x32_bf16 v[72:75], v[28:31], v[232:235], 0
    s_add_u32 s72, s85, 147456
    s_sub_u32 s99, s72, 393216
    s_cselect_b32 s72, s72, s99
    s_waitcnt lgkmcnt(0)
    v_readfirstlane_b32 s98, v251
    s_cmp_ge_u32 s98, 128
    s_cselect_b64 vcc, -1, 0
    s_cmp_gt_u32 s98, 135
    s_cbranch_scc1 L_w4_22_0
    s_cbranch_vccnz L_w3_22_0
    s_waitcnt vmcnt(1)
L_w3_22_0:
    s_waitcnt vmcnt(2)
L_w4_22_0:
    s_waitcnt vmcnt(3)
    buffer_load_dwordx4 v[224:227], v2, s[44:47], s72 offen nt
    s_cbranch_scc1 L_w4_22_1
    s_cbranch_vccnz L_w3_22_1
    s_waitcnt vmcnt(1)
L_w3_22_1:
    s_waitcnt vmcnt(2)
L_w4_22_1:
    s_waitcnt vmcnt(3)
    buffer_load_dwordx4 v[228:231], v2, s[44:47], s72 offen offset:128 nt
    s_cbranch_scc1 L_w4_22_2
    s_cbranch_vccnz L_w3_22_2
    s_waitcnt vmcnt(1)
L_w3_22_2:
    s_waitcnt vmcnt(2)
L_w4_22_2:
    s_waitcnt vmcnt(3)
    buffer_load_dwordx4 v[232:235], v2, s[44:47], s72 offen offset:256 nt
    s_mov_b64 exec, 1
    ds_add_rtn_u32 v251, v252, v255 offset:3140
    s_mov_b64 exec, -1
    v_and_b32 v32, v49, v3
    v_and_b32 v33, v49, v4
    v_and_b32 v34, v49, v5
    v_and_b32 v35, v49, v6
    s_nop 1
    v_mfma_f32_16x16x32_bf16 v[64:67], v[32:35], v[236:239], v[64:67]
    v_mfma_f32_16x16x32_bf16 v[68:71], v[32:35], v[240:243], v[68:71]
    v_mfma_f32_16x16x32_bf16 v[72:75], v[32:35], v[244:247], v[72:75]
    s_add_u32 s72, s85, 172032
    s_sub_u32 s99, s72, 393216
    s_cselect_b32 s72, s72, s99
    s_waitcnt lgkmcnt(0)
    v_readfirstlane_b32 s98, v251
    s_cmp_ge_u32 s98, 136
    s_cselect_b64 vcc, -1, 0
    s_cmp_gt_u32 s98, 143
    s_cbranch_scc1 L_w4_23_0
    s_cbranch_vccnz L_w3_23_0
    s_waitcnt vmcnt(1)
L_w3_23_0:
    s_waitcnt vmcnt(2)
L_w4_23_0:
    s_waitcnt vmcnt(3)
    buffer_load_dwordx4 v[236:239], v2, s[44:47], s72 offen nt
    s_cbranch_scc1 L_w4_23_1
    s_cbranch_vccnz L_w3_23_1
    s_waitcnt vmcnt(1)
L_w3_23_1:
    s_waitcnt vmcnt(2)
L_w4_23_1:
    s_waitcnt vmcnt(3)
    buffer_load_dwordx4 v[240:243], v2, s[44:47], s72 offen offset:128 nt
    s_cbranch_scc1 L_w4_23_2
    s_cbranch_vccnz L_w3_23_2
    s_waitcnt vmcnt(1)
L_w3_23_2:
    s_waitcnt vmcnt(2)
L_w4_23_2:
    s_waitcnt vmcnt(3)
    buffer_load_dwordx4 v[244:247], v2, s[44:47], s72 offen offset:256 nt
L_ffchk:
    s_mov_b32 s82, 0x3f3f3f3f
    s_mov_b32 s83, 0x3f3f3f3f
    s_mov_b64 exec, s[82:83]
    v_cmpx_eq_u32 vcc, s7, v77
    v_cmpx_eq_u32 vcc, s7, v79
    v_cmpx_eq_u32 vcc, s7, v81
    v_cmpx_eq_u32 vcc, s7, v83
    s_cmp_eq_u64 exec, s[82:83]
    s_mov_b64 exec, -1
    s_cbranch_scc1 L_ffok
    buffer_load_dwordx4 v[76:79], v7, s[60:63], s78 offen sc1
    buffer_load_dwordx4 v[80:83], v7, s[60:63], s79 offen sc1
    s_waitcnt vmcnt(0)
    s_sub_u32 s15, s15, 1
    s_cmp_lg_u32 s15, 0
    s_cbranch_scc1 L_ffchk
L_ffok:
    s_nop 1
    v_readlane_b32 s10, v76, 6
    v_readlane_b32 s11, v77, 6
    v_mov_b32 v254, 0
    s_cmp_eq_u32 s10, s100
    s_cselect_b32 s10, 1, 0
    s_cmp_eq_u32 s11, s7
    s_cselect_b32 s10, s10, 0
    v_mov_b32 v253, s10
    s_mov_b64 exec, 1
    ds_add_u32 v254, v253 offset:3144
    s_mov_b64 exec, -1
    v_lshlrev_b32 v9, 3, v1
    s_lshl_b32 s8, s3, 10
    v_add_u32 v9, s8, v9
    v_mov_b32 v77, v78
    v_mov_b32 v81, v82
    ds_write_b64 v9, v[76:77] offset:4096
    ds_write_b64 v9, v[80:81] offset:4608
    s_mov_b64 exec, 1
    ds_add_rtn_u32 v251, v252, v255 offset:3140
    s_mov_b64 exec, -1
    v_and_b32 v28, v50, v3
    v_and_b32 v29, v50, v4
    v_and_b32 v30, v50, v5
    v_and_b32 v31, v50, v6
    s_nop 1
    v_mfma_f32_16x16x32_bf16 v[64:67], v[28:31], v[176:179], v[64:67]
    v_mfma_f32_16x16x32_bf16 v[68:71], v[28:31], v[180:183], v[68:71]
    v_mfma_f32_16x16x32_bf16 v[72:75], v[28:31], v[184:187], v[72:75]
    s_add_u32 s72, s85, 196608
    s_sub_u32 s99, s72, 393216
    s_cselect_b32 s72, s72, s99
    s_waitcnt lgkmcnt(0)
    v_readfirstlane_b32 s98, v251
    s_cmp_ge_u32 s98, 144
    s_cselect_b64 vcc, -1, 0
    s_cmp_gt_u32 s98, 151
    s_cbranch_scc1 L_w4_24_0
    s_cbranch_vccnz L_w3_24_0
    s_waitcnt vmcnt(1)
L_w3_24_0:
    s_waitcnt vmcnt(2)
L_w4_24_0:
    s_waitcnt vmcnt(3)
    buffer_load_dwordx4 v[176:179], v2, s[44:47], s72 offen nt
    s_cbranch_scc1 L_w4_24_1
    s_cbranch_vccnz L_w3_24_1
    s_waitcnt vmcnt(1)
L_w3_24_1:
    s_waitcnt vmcnt(2)
L_w4_24_1:
    s_waitcnt vmcnt(3)
    buffer_load_dwordx4 v[180:183], v2, s[44:47], s72 offen offset:128 nt
    s_cbranch_scc1 L_w4_24_2
    s_cbranch_vccnz L_w3_24_2
    s_waitcnt vmcnt(1)
L_w3_24_2:
    s_waitcnt vmcnt(2)
L_w4_24_2:
    s_waitcnt vmcnt(3)
    buffer_load_dwordx4 v[184:187], v2, s[44:47], s72 offen offset:256 nt
    s_mov_b64 exec, 1
    ds_add_rtn_u32 v251, v252, v255 offset:3140
    s_mov_b64 exec, -1
    v_and_b32 v32, v51, v3
    v_and_b32 v33, v51, v4
    v_and_b32 v34, v51, v5
    v_and_b32 v35, v51, v6
    s_nop 1
    v_mfma_f32_16x16x32_bf16 v[64:67], v[32:35], v[188:191], v[64:67]
    v_mfma_f32_16x16x32_bf16 v[68:71], v[32:35], v[192:195], v[68:71]
    v_mfma_f32_16x16x32_bf16 v[72:75], v[32:35], v[196:199], v[72:75]
    s_add_u32 s72, s85, 221184
    s_sub_u32 s99, s72, 393216
    s_cselect_b32 s72, s72, s99
    s_waitcnt lgkmcnt(0)
    v_readfirstlane_b32 s98, v251
    s_cmp_ge_u32 s98, 152
    s_cselect_b64 vcc, -1, 0
    s_cmp_gt_u32 s98, 159
    s_cbranch_scc1 L_w4_25_0
    s_cbranch_vccnz L_w3_25_0
    s_waitcnt vmcnt(1)
L_w3_25_0:
    s_waitcnt vmcnt(2)
L_w4_25_0:
    s_waitcnt vmcnt(3)
    buffer_load_dwordx4 v[188:191], v2, s[44:47], s72 offen nt
    s_cbranch_scc1 L_w4_25_1
    s_cbranch_vccnz L_w3_25_1
    s_waitcnt vmcnt(1)
L_w3_25_1:
    s_waitcnt vmcnt(2)
L_w4_25_1:
    s_waitcnt vmcnt(3)
    buffer_load_dwordx4 v[192:195], v2, s[44:47], s72 offen offset:128 nt
    s_cbranch_scc1 L_w4_25_2
    s_cbranch_vccnz L_w3_25_2
    s_waitcnt vmcnt(1)
L_w3_25_2:
    s_waitcnt vmcnt(2)
L_w4_25_2:
    s_waitcnt vmcnt(3)
    buffer_load_dwordx4 v[196:199], v2, s[44:47], s72 offen offset:256 nt
    s_mov_b64 exec, 1
    ds_add_rtn_u32 v251, v252, v255 offset:3140
    s_mov_b64 exec, -1
    v_and_b32 v28, v52, v3
    v_and_b32 v29, v52, v4
    v_and_b32 v30, v52, v5
    v_and_b32 v31, v52, v6
    s_nop 1
    v_mfma_f32_16x16x32_bf16 v[64:67], v[28:31], v[200:203], v[64:67]
    v_mfma_f32_16x16x32_bf16 v[68:71], v[28:31], v[204:207], v[68:71]
    v_mfma_f32_16x16x32_bf16 v[72:75], v[28:31], v[208:211], v[72:75]
    s_add_u32 s72, s85, 245760
    s_sub_u32 s99, s72, 393216
    s_cselect_b32 s72, s72, s99
    s_waitcnt lgkmcnt(0)
    v_readfirstlane_b32 s98, v251
    s_cmp_ge_u32 s98, 160
    s_cselect_b64 vcc, -1, 0
    s_cmp_gt_u32 s98, 167
    s_cbranch_scc1 L_w4_26_0
    s_cbranch_vccnz L_w3_26_0
    s_waitcnt vmcnt(1)
L_w3_26_0:
    s_waitcnt vmcnt(2)
L_w4_26_0:
    s_waitcnt vmcnt(3)
    buffer_load_dwordx4 v[200:203], v2, s[44:47], s72 offen nt
    s_cbranch_scc1 L_w4_26_1
    s_cbranch_vccnz L_w3_26_1
    s_waitcnt vmcnt(1)
L_w3_26_1:
    s_waitcnt vmcnt(2)
L_w4_26_1:
    s_waitcnt vmcnt(3)
    buffer_load_dwordx4 v[204:207], v2, s[44:47], s72 offen offset:128 nt
    s_cbranch_scc1 L_w4_26_2
    s_cbranch_vccnz L_w3_26_2
    s_waitcnt vmcnt(1)
L_w3_26_2:
    s_waitcnt vmcnt(2)
L_w4_26_2:
    s_waitcnt vmcnt(3)
    buffer_load_dwordx4 v[208:211], v2, s[44:47], s72 offen offset:256 nt
    s_mov_b64 exec, 1
    ds_add_rtn_u32 v251, v252, v255 offset:3140
    s_mov_b64 exec, -1
    v_and_b32 v32, v53, v3
    v_and_b32 v33, v53, v4
    v_and_b32 v34, v53, v5
    v_and_b32 v35, v53, v6
    s_nop 1
    v_mfma_f32_16x16x32_bf16 v[64:67], v[32:35], v[212:215], v[64:67]
    v_mfma_f32_16x16x32_bf16 v[68:71], v[32:35], v[216:219], v[68:71]
    v_mfma_f32_16x16x32_bf16 v[72:75], v[32:35], v[220:223], v[72:75]
    s_add_u32 s72, s85, 270336
    s_sub_u32 s99, s72, 393216
    s_cselect_b32 s72, s72, s99
    s_waitcnt lgkmcnt(0)
    v_readfirstlane_b32 s98, v251
    s_cmp_ge_u32 s98, 168
    s_cselect_b64 vcc, -1, 0
    s_cmp_gt_u32 s98, 175
    s_cbranch_scc1 L_w4_27_0
    s_cbranch_vccnz L_w3_27_0
    s_waitcnt vmcnt(1)
L_w3_27_0:
    s_waitcnt vmcnt(2)
L_w4_27_0:
    s_waitcnt vmcnt(3)
    buffer_load_dwordx4 v[212:215], v2, s[44:47], s72 offen nt
    s_cbranch_scc1 L_w4_27_1
    s_cbranch_vccnz L_w3_27_1
    s_waitcnt vmcnt(1)
L_w3_27_1:
    s_waitcnt vmcnt(2)
L_w4_27_1:
    s_waitcnt vmcnt(3)
    buffer_load_dwordx4 v[216:219], v2, s[44:47], s72 offen offset:128 nt
    s_cbranch_scc1 L_w4_27_2
    s_cbranch_vccnz L_w3_27_2
    s_waitcnt vmcnt(1)
L_w3_27_2:
    s_waitcnt vmcnt(2)
L_w4_27_2:
    s_waitcnt vmcnt(3)
    buffer_load_dwordx4 v[220:223], v2, s[44:47], s72 offen offset:256 nt
    s_mov_b64 exec, 1
    ds_add_rtn_u32 v251, v252, v255 offset:3140
    s_mov_b64 exec, -1
    v_and_b32 v28, v54, v3
    v_and_b32 v29, v54, v4
    v_and_b32 v30, v54, v5
    v_and_b32 v31, v54, v6
    s_nop 1
    v_mfma_f32_16x16x32_bf16 v[64:67], v[28:31], v[224:227], v[64:67]
    v_mfma_f32_16x16x32_bf16 v[68:71], v[28:31], v[228:231], v[68:71]
    v_mfma_f32_16x16x32_bf16 v[72:75], v[28:31], v[232:235], v[72:75]
    s_add_u32 s72, s85, 294912
    s_sub_u32 s99, s72, 393216
    s_cselect_b32 s72, s72, s99
    s_waitcnt lgkmcnt(0)
    v_readfirstlane_b32 s98, v251
    s_cmp_ge_u32 s98, 176
    s_cselect_b64 vcc, -1, 0
    s_cmp_gt_u32 s98, 183
    s_cbranch_scc1 L_w4_28_0
    s_cbranch_vccnz L_w3_28_0
    s_waitcnt vmcnt(1)
L_w3_28_0:
    s_waitcnt vmcnt(2)
L_w4_28_0:
    s_waitcnt vmcnt(3)
    buffer_load_dwordx4 v[224:227], v2, s[44:47], s72 offen nt
    s_cbranch_scc1 L_w4_28_1
    s_cbranch_vccnz L_w3_28_1
    s_waitcnt vmcnt(1)
L_w3_28_1:
    s_waitcnt vmcnt(2)
L_w4_28_1:
    s_waitcnt vmcnt(3)
    buffer_load_dwordx4 v[228:231], v2, s[44:47], s72 offen offset:128 nt
    s_cbranch_scc1 L_w4_28_2
    s_cbranch_vccnz L_w3_28_2
    s_waitcnt vmcnt(1)
L_w3_28_2:
    s_waitcnt vmcnt(2)
L_w4_28_2:
    s_waitcnt vmcnt(3)
    buffer_load_dwordx4 v[232:235], v2, s[44:47], s72 offen offset:256 nt
    v_and_b32 v32, v55, v3
    v_and_b32 v33, v55, v4
    v_and_b32 v34, v55, v5
    v_and_b32 v35, v55, v6
    s_nop 1
    v_mfma_f32_16x16x32_bf16 v[64:67], v[32:35], v[236:239], v[64:67]
    v_mfma_f32_16x16x32_bf16 v[68:71], v[32:35], v[240:243], v[68:71]
    v_mfma_f32_16x16x32_bf16 v[72:75], v[32:35], v[244:247], v[72:75]
    s_add_u32 s72, s85, 319488
    s_sub_u32 s99, s72, 393216
    s_cselect_b32 s72, s72, s99
    s_waitcnt vmcnt(8)
    buffer_load_dwordx4 v[236:239], v2, s[44:47], s72 offen nt
    s_waitcnt vmcnt(8)
    buffer_load_dwordx4 v[240:243], v2, s[44:47], s72 offen offset:128 nt
    s_waitcnt vmcnt(8)
    buffer_load_dwordx4 v[244:247], v2, s[44:47], s72 offen offset:256 nt
    v_and_b32 v28, v56, v3
    v_and_b32 v29, v56, v4
    v_and_b32 v30, v56, v5
    v_and_b32 v31, v56, v6
    s_nop 1
    v_mfma_f32_16x16x32_bf16 v[64:67], v[28:31], v[176:179], v[64:67]
    v_mfma_f32_16x16x32_bf16 v[68:71], v[28:31], v[180:183], v[68:71]
    v_mfma_f32_16x16x32_bf16 v[72:75], v[28:31], v[184:187], v[72:75]
    s_add_u32 s72, s85, 344064
    s_sub_u32 s99, s72, 393216
    s_cselect_b32 s72, s72, s99
    s_waitcnt vmcnt(8)
    buffer_load_dwordx4 v[176:179], v2, s[44:47], s72 offen nt
    s_waitcnt vmcnt(8)
    buffer_load_dwordx4 v[180:183], v2, s[44:47], s72 offen offset:128 nt
    s_waitcnt vmcnt(8)
    buffer_load_dwordx4 v[184:187], v2, s[44:47], s72 offen offset:256 nt
    v_and_b32 v32, v57, v3
    v_and_b32 v33, v57, v4
    v_and_b32 v34, v57, v5
    v_and_b32 v35, v57, v6
    s_nop 1
    v_mfma_f32_16x16x32_bf16 v[64:67], v[32:35], v[188:191], v[64:67]
    v_mfma_f32_16x16x32_bf16 v[68:71], v[32:35], v[192:195], v[68:71]
    v_mfma_f32_16x16x32_bf16 v[72:75], v[32:35], v[196:199], v[72:75]
    s_add_u32 s72, s85, 368640
    s_sub_u32 s99, s72, 393216
    s_cselect_b32 s72, s72, s99
    s_waitcnt vmcnt(8)
    buffer_load_dwordx4 v[188:191], v2, s[44:47], s72 offen nt
    s_waitcnt vmcnt(8)
    buffer_load_dwordx4 v[192:195], v2, s[44:47], s72 offen offset:128 nt
    s_waitcnt vmcnt(8)
    buffer_load_dwordx4 v[196:199], v2, s[44:47], s72 offen offset:256 nt
    v_and_b32 v28, v58, v3
    v_and_b32 v29, v58, v4
    v_and_b32 v30, v58, v5
    v_and_b32 v31, v58, v6
    s_nop 1
    v_mfma_f32_16x16x32_bf16 v[64:67], v[28:31], v[200:203], v[64:67]
    v_mfma_f32_16x16x32_bf16 v[68:71], v[28:31], v[204:207], v[68:71]
    v_mfma_f32_16x16x32_bf16 v[72:75], v[28:31], v[208:211], v[72:75]
    v_and_b32 v32, v59, v3
    v_and_b32 v33, v59, v4
    v_and_b32 v34, v59, v5
    v_and_b32 v35, v59, v6
    s_nop 1
    v_mfma_f32_16x16x32_bf16 v[64:67], v[32:35], v[212:215], v[64:67]
    v_mfma_f32_16x16x32_bf16 v[68:71], v[32:35], v[216:219], v[68:71]
    v_mfma_f32_16x16x32_bf16 v[72:75], v[32:35], v[220:223], v[72:75]
    v_and_b32 v28, v60, v3
    v_and_b32 v29, v60, v4
    v_and_b32 v30, v60, v5
    v_and_b32 v31, v60, v6
    s_nop 1
    v_mfma_f32_16x16x32_bf16 v[64:67], v[28:31], v[224:227], v[64:67]
    v_mfma_f32_16x16x32_bf16 v[68:71], v[28:31], v[228:231], v[68:71]
    v_mfma_f32_16x16x32_bf16 v[72:75], v[28:31], v[232:235], v[72:75]
    v_and_b32 v32, v61, v3
    v_and_b32 v33, v61, v4
    v_and_b32 v34, v61, v5
    v_and_b32 v35, v61, v6
    s_waitcnt vmcnt(6)
    s_nop 0
    v_mfma_f32_16x16x32_bf16 v[64:67], v[32:35], v[236:239], v[64:67]
    v_mfma_f32_16x16x32_bf16 v[68:71], v[32:35], v[240:243], v[68:71]
    v_mfma_f32_16x16x32_bf16 v[72:75], v[32:35], v[244:247], v[72:75]
    v_and_b32 v28, v62, v3
    v_and_b32 v29, v62, v4
    v_and_b32 v30, v62, v5
    v_and_b32 v31, v62, v6
    s_waitcnt vmcnt(3)
    s_nop 0
    v_mfma_f32_16x16x32_bf16 v[64:67], v[28:31], v[176:179], v[64:67]
    v_mfma_f32_16x16x32_bf16 v[68:71], v[28:31], v[180:183], v[68:71]
    v_mfma_f32_16x16x32_bf16 v[72:75], v[28:31], v[184:187], v[72:75]
    ds_read_b32 v253, v254 offset:3144
    v_and_b32 v32, v63, v3
    v_and_b32 v33, v63, v4
    v_and_b32 v34, v63, v5
    v_and_b32 v35, v63, v6
    s_waitcnt vmcnt(0)
    s_nop 0
    v_mfma_f32_16x16x32_bf16 v[64:67], v[32:35], v[188:191], v[64:67]
    v_mfma_f32_16x16x32_bf16 v[68:71], v[32:35], v[192:195], v[68:71]
    v_mfma_f32_16x16x32_bf16 v[72:75], v[32:35], v[196:199], v[72:75]
    s_waitcnt lgkmcnt(0)
    v_readfirstlane_b32 s101, v253
    s_mov_b32 exec_lo, 0x00ff00ff
    s_mov_b32 exec_hi, 0xff00ff00
    s_nop 1
    ds_write_b128 v26, v[64:67] offset:12288
    ds_write_b128 v26, v[68:71] offset:12544
    ds_write_b128 v26, v[72:75] offset:12800
    s_mov_b64 exec, -1
    s_lshl_b32 s8, s4, 3
    s_lshl_b32 s78, s8, 11
    s_add_u32 s78, s78, 1314816
    s_lshl_b32 s9, s5, 11
    s_add_u32 s9, s9, s78
    s_add_u32 s79, s78, 4096
    s_add_u32 s80, s78, 8192
    s_add_u32 s81, s78, 12288
    s_waitcnt lgkmcnt(0)
    s_barrier
    s_cmp_lt_u32 s3, 3
    s_cbranch_scc0 L_notg2
    v_mov_b32 v9, 0
    ds_read_b128 v[208:211], v9 offset:3072
    ds_read_b128 v[212:215], v9 offset:3088
    s_cmp_eq_u32 s3, 2
    s_cbranch_scc1 L_pubml
    v_lshlrev_b32 v9, 3, v0
    ds_read_b64 v[176:177], v9 offset:12288
    ds_read_b64 v[178:179], v9 offset:13056
    ds_read_b64 v[180:181], v9 offset:13824
    ds_read_b64 v[182:183], v9 offset:14592
    ds_read_b64 v[184:185], v9 offset:15360
    ds_read_b64 v[186:187], v9 offset:16128
    ds_read_b64 v[188:189], v9 offset:16896
    ds_read_b64 v[190:191], v9 offset:17664
    ds_read_b64 v[192:193], v9 offset:18432
    ds_read_b64 v[194:195], v9 offset:19200
    ds_read_b64 v[196:197], v9 offset:19968
    ds_read_b64 v[198:199], v9 offset:20736
    ds_read_b64 v[200:201], v9 offset:21504
    ds_read_b64 v[202:203], v9 offset:22272
    ds_read_b64 v[204:205], v9 offset:23040
    ds_read_b64 v[206:207], v9 offset:23808
    s_waitcnt lgkmcnt(15)
    v_max3_f32 v12, v208, v209, v210
    v_max3_f32 v13, v211, v212, v213
    v_max3_f32 v12, v12, v214, v215
    v_max_f32 v24, v12, v13
    v_sub_f32 v208, v208, v24
    v_sub_f32 v209, v209, v24
    v_sub_f32 v210, v210, v24
    v_sub_f32 v211, v211, v24
    v_sub_f32 v212, v212, v24
    v_sub_f32 v213, v213, v24
    v_sub_f32 v214, v214, v24
    v_sub_f32 v215, v215, v24
    v_mul_f32 v208, s76, v208
    v_mul_f32 v209, s76, v209
    v_mul_f32 v210, s76, v210
    v_mul_f32 v211, s76, v211
    v_mul_f32 v212, s76, v212
    v_mul_f32 v213, s76, v213
    v_mul_f32 v214, s76, v214
    v_mul_f32 v215, s76, v215
    v_exp_f32 v208, v208
    v_exp_f32 v209, v209
    v_exp_f32 v210, v210
    v_exp_f32 v211, v211
    v_exp_f32 v212, v212
    v_exp_f32 v213, v213
    v_exp_f32 v214, v214
    v_exp_f32 v215, v215
    v_lshlrev_b32 v10, 4, v0
    s_waitcnt lgkmcnt(0)
    v_pk_add_f32 v[176:177], v[176:177], v[178:179]
    v_pk_add_f32 v[180:181], v[180:181], v[182:183]
    v_pk_add_f32 v[184:185], v[184:185], v[186:187]
    v_pk_add_f32 v[188:189], v[188:189], v[190:191]
    v_pk_add_f32 v[192:193], v[192:193], v[194:195]
    v_pk_add_f32 v[196:197], v[196:197], v[198:199]
    v_pk_add_f32 v[200:201], v[200:201], v[202:203]
    v_pk_add_f32 v[204:205], v[204:205], v[206:207]
    v_pk_mul_f32 v[176:177], v[176:177], v[208:209] op_sel:[0,0] op_sel_hi:[1,0]
    v_pk_mul_f32 v[180:181], v[180:181], v[208:209] op_sel:[0,1] op_sel_hi:[1,1]
    v_pk_fma_f32 v[176:177], v[184:185], v[210:211], v[176:177] op_sel:[0,0,0] op_sel_hi:[1,0,1]
    v_pk_fma_f32 v[180:181], v[188:189], v[210:211], v[180:181] op_sel:[0,1,0] op_sel_hi:[1,1,1]
    v_pk_fma_f32 v[176:177], v[192:193], v[212:213], v[176:177] op_sel:[0,0,0] op_sel_hi:[1,0,1]
    v_pk_fma_f32 v[180:181], v[196:197], v[212:213], v[180:181] op_sel:[0,1,0] op_sel_hi:[1,1,1]
    v_pk_fma_f32 v[176:177], v[200:201], v[214:215], v[176:177] op_sel:[0,0,0] op_sel_hi:[1,0,1]
    v_pk_fma_f32 v[180:181], v[204:205], v[214:215], v[180:181] op_sel:[0,1,0] op_sel_hi:[1,1,1]
    v_add_f32 v12, v176, v180
    v_add_f32 v14, v177, v181
    v_mov_b32 v13, s7
    v_mov_b32 v15, s7
    v_cmp_gt_u32 vcc, 96, v0
    s_and_b64 exec, exec, vcc
    s_cmp_eq_u32 s101, 8
    s_cbranch_scc0 L_fara
    buffer_store_dwordx4 v[12:15], v10, s[60:63], s9 offen
    s_branch L_neara
L_fara:
    buffer_store_dwordx4 v[12:15], v10, s[60:63], s9 offen sc1
L_neara:
    s_mov_b64 exec, -1
    s_branch L_g2
L_pubml:
    v_mov_b32 v9, 0
    ds_read_b128 v[176:179], v9 offset:3104
    ds_read_b128 v[180:183], v9 offset:3120
    s_waitcnt lgkmcnt(2)
    v_max3_f32 v12, v208, v209, v210
    v_max3_f32 v13, v211, v212, v213
    v_max3_f32 v12, v12, v214, v215
    v_max_f32 v24, v12, v13
    v_sub_f32 v208, v208, v24
    v_sub_f32 v209, v209, v24
    v_sub_f32 v210, v210, v24
    v_sub_f32 v211, v211, v24
    v_sub_f32 v212, v212, v24
    v_sub_f32 v213, v213, v24
    v_sub_f32 v214, v214, v24
    v_sub_f32 v215, v215, v24
    v_mul_f32 v208, s76, v208
    v_mul_f32 v209, s76, v209
    v_mul_f32 v210, s76, v210
    v_mul_f32 v211, s76, v211
    v_mul_f32 v212, s76, v212
    v_mul_f32 v213, s76, v213
    v_mul_f32 v214, s76, v214
    v_mul_f32 v215, s76, v215
    v_exp_f32 v208, v208
    v_exp_f32 v209, v209
    v_exp_f32 v210, v210
    v_exp_f32 v211, v211
    v_exp_f32 v212, v212
    v_exp_f32 v213, v213
    v_exp_f32 v214, v214
    v_exp_f32 v215, v215
    v_mov_b32 v13, s7
    v_mov_b32 v15, s7
    v_mov_b32 v10, 1536
    s_waitcnt lgkmcnt(0)
    v_pk_mul_f32 v[176:177], v[176:177], v[208:209]
    v_pk_mul_f32 v[178:179], v[178:179], v[210:211]
    v_pk_mul_f32 v[180:181], v[180:181], v[212:213]
    v_pk_mul_f32 v[182:183], v[182:183], v[214:215]
    v_pk_add_f32 v[176:177], v[176:177], v[178:179]
    v_pk_add_f32 v[180:181], v[180:181], v[182:183]
    v_pk_add_f32 v[176:177], v[176:177], v[180:181]
    v_mov_b32 v12, v24
    v_add_f32 v14, v176, v177
    s_mov_b64 exec, 1
    s_cmp_eq_u32 s101, 8
    s_cbranch_scc0 L_farb
    buffer_store_dwordx4 v[12:15], v10, s[60:63], s9 offen
    s_branch L_nearb
L_farb:
    buffer_store_dwordx4 v[12:15], v10, s[60:63], s9 offen sc1
L_nearb:
    s_mov_b64 exec, -1
L_g2:
    v_cmp_le_u32 vcc, 96, v0
    s_nop 1
    v_cndmask_b32 v9, 0, 1, vcc
    v_mul_u32_u24 v10, 96, v9
    v_sub_u32 v10, v0, v10
    v_lshlrev_b32 v11, 11, v9
    v_lshl_add_u32 v16, v10, 4, v11
    v_add_u32 v17, 1536, v11
    v_mul_u32_u24 v18, 480, v9
    v_lshl_add_u32 v18, v10, 2, v18
L_g2l:
    buffer_load_dwordx4 v[192:195], v17, s[60:63], s78 offen sc1
    buffer_load_dwordx4 v[176:179], v16, s[60:63], s78 offen sc1
    buffer_load_dwordx4 v[196:199], v17, s[60:63], s79 offen sc1
    buffer_load_dwordx4 v[180:183], v16, s[60:63], s79 offen sc1
    buffer_load_dwordx4 v[200:203], v17, s[60:63], s80 offen sc1
    buffer_load_dwordx4 v[184:187], v16, s[60:63], s80 offen sc1
    buffer_load_dwordx4 v[204:207], v17, s[60:63], s81 offen sc1
    buffer_load_dwordx4 v[188:191], v16, s[60:63], s81 offen sc1
    s_waitcnt vmcnt(0)
    v_cmpx_eq_u32 vcc, s7, v177
    v_cmpx_eq_u32 vcc, s7, v179
    v_cmpx_eq_u32 vcc, s7, v181
    v_cmpx_eq_u32 vcc, s7, v183
    v_cmpx_eq_u32 vcc, s7, v185
    v_cmpx_eq_u32 vcc, s7, v187
    v_cmpx_eq_u32 vcc, s7, v189
    v_cmpx_eq_u32 vcc, s7, v191
    v_cmpx_eq_u32 vcc, s7, v193
    v_cmpx_eq_u32 vcc, s7, v195
    v_cmpx_eq_u32 vcc, s7, v197
    v_cmpx_eq_u32 vcc, s7, v199
    v_cmpx_eq_u32 vcc, s7, v201
    v_cmpx_eq_u32 vcc, s7, v203
    v_cmpx_eq_u32 vcc, s7, v205
    v_cmpx_eq_u32 vcc, s7, v207
    s_cmp_eq_u64 exec, -1
    s_mov_b64 exec, -1
    s_cbranch_scc1 L_g2ok
    s_sub_u32 s15, s15, 1
    s_cmp_lg_u32 s15, 0
    s_cbranch_scc1 L_g2l
L_g2ok:
    v_max3_f32 v9, v192, v196, v200
    v_max_f32 v9, v9, v204
    v_sub_f32 v192, v192, v9
    v_sub_f32 v196, v196, v9
    v_sub_f32 v200, v200, v9
    v_sub_f32 v204, v204, v9
    v_mul_f32 v192, s76, v192
    v_mul_f32 v196, s76, v196
    v_mul_f32 v200, s76, v200
    v_mul_f32 v204, s76, v204
    v_exp_f32 v192, v192
    v_exp_f32 v196, v196
    v_exp_f32 v200, v200
    v_exp_f32 v204, v204
    v_mul_f32 v9, v192, v194
    v_mul_f32 v10, v192, v176
    v_mul_f32 v11, v192, v178
    v_fmac_f32 v9, v196, v198
    v_fmac_f32 v10, v196, v180
    v_fmac_f32 v11, v196, v182
    v_fmac_f32 v9, v200, v202
    v_fmac_f32 v10, v200, v184
    v_fmac_f32 v11, v200, v186
    v_fmac_f32 v9, v204, v206
    v_fmac_f32 v10, v204, v188
    v_fmac_f32 v11, v204, v190
    v_rcp_f32 v9, v9
    s_nop 0
    v_mul_f32 v10, v10, v9
    v_mul_f32 v11, v11, v9
    v_cvt_pk_bf16_f32 v10, v10, v11
    ds_write_b32 v18, v10 offset:24576
    s_branch L_b4
L_notg2:
    s_cmp_eq_u32 s3, 3
    s_cbranch_scc0 L_b4
    v_lshlrev_b32 v9, 3, v1
    ds_read_b64 v[176:177], v9 offset:4096
    ds_read_b64 v[192:193], v9 offset:4608
    ds_read_b64 v[178:179], v9 offset:5120
    ds_read_b64 v[194:195], v9 offset:5632
    ds_read_b64 v[180:181], v9 offset:6144
    ds_read_b64 v[196:197], v9 offset:6656
    ds_read_b64 v[182:183], v9 offset:7168
    ds_read_b64 v[198:199], v9 offset:7680
    ds_read_b64 v[184:185], v9 offset:8192
    ds_read_b64 v[200:201], v9 offset:8704
    ds_read_b64 v[186:187], v9 offset:9216
    ds_read_b64 v[202:203], v9 offset:9728
    ds_read_b64 v[188:189], v9 offset:10240
    ds_read_b64 v[204:205], v9 offset:10752
    ds_read_b64 v[190:191], v9 offset:11264
    ds_read_b64 v[206:207], v9 offset:11776
    s_waitcnt lgkmcnt(0)
    v_pk_add_f32 v[176:177], v[176:177], v[184:185]
    v_pk_add_f32 v[178:179], v[178:179], v[186:187]
    v_pk_add_f32 v[180:181], v[180:181], v[188:189]
    v_pk_add_f32 v[182:183], v[182:183], v[190:191]
    v_pk_add_f32 v[176:177], v[176:177], v[180:181]
    v_pk_add_f32 v[178:179], v[178:179], v[182:183]
    v_pk_add_f32 v[176:177], v[176:177], v[178:179]
    v_pk_add_f32 v[192:193], v[192:193], v[200:201]
    v_pk_add_f32 v[194:195], v[194:195], v[202:203]
    v_pk_add_f32 v[196:197], v[196:197], v[204:205]
    v_pk_add_f32 v[198:199], v[198:199], v[206:207]
    v_pk_add_f32 v[192:193], v[192:193], v[196:197]
    v_pk_add_f32 v[194:195], v[194:195], v[198:199]
    v_pk_add_f32 v[192:193], v[192:193], v[194:195]
    v_cvt_pk_bf16_f32 v10, v176, v177
    v_cvt_pk_bf16_f32 v11, v192, v193
    v_lshlrev_b32 v176, 16, v10
    v_and_b32 v177, s95, v10
    v_lshlrev_b32 v178, 16, v11
    v_and_b32 v179, s95, v11
    v_mov_b32 v12, 0x3d372713
    v_mov_b32 v13, 0xc0135761
    v_mul_f32 v14, v176, v176
    v_mul_f32 v14, v14, v176
    v_fma_f32 v14, v14, v12, v176
    v_mul_f32 v14, v14, v13
    v_exp_f32 v14, v14
    s_nop 0
    v_add_f32 v14, 1.0, v14
    v_rcp_f32 v14, v14
    s_nop 0
    v_mul_f32 v14, v14, v176
    v_mul_f32 v15, v177, v177
    v_mul_f32 v15, v15, v177
    v_fma_f32 v15, v15, v12, v177
    v_mul_f32 v15, v15, v13
    v_exp_f32 v15, v15
    s_nop 0
    v_add_f32 v15, 1.0, v15
    v_rcp_f32 v15, v15
    s_nop 0
    v_mul_f32 v15, v15, v177
    v_cvt_pk_bf16_f32 v10, v14, v15
    v_lshlrev_b32 v176, 16, v10
    v_and_b32 v177, s95, v10
    v_mul_f32 v176, v176, v178
    v_mul_f32 v177, v177, v179
    v_cvt_pk_bf16_f32 v10, v176, v177
    v_lshrrev_b32 v11, 5, v1
    v_mul_u32_u24 v11, 480, v11
    v_and_b32 v12, 7, v1
    v_lshl_add_u32 v11, v12, 4, v11
    v_bfe_u32 v12, v1, 4, 1
    v_lshl_add_u32 v11, v12, 3, v11
    v_bfe_u32 v12, v1, 3, 1
    v_lshl_add_u32 v11, v12, 2, v11
    s_mov_b32 exec_lo, 0x3f3f3f3f
    s_mov_b32 exec_hi, 0x3f3f3f3f
    ds_write_b32 v11, v10 offset:24960
    s_mov_b64 exec, -1
L_b4:
    v_bfe_u32 v9, v1, 3, 1
    v_mul_u32_u24 v9, 480, v9
    v_lshrrev_b32 v10, 4, v1
    v_mul_u32_u24 v11, 12, v10
    s_mul_i32 s8, s3, 48
    v_add3_u32 v11, v11, v9, s8
    v_lshlrev_b32 v10, 2, v10
    s_lshl_b32 s8, s3, 4
    v_add3_u32 v10, v10, v9, s8
    s_waitcnt lgkmcnt(0)
    s_barrier
    v_add_u32 v11, 24576, v11
    v_add_u32 v10, 24960, v10
    ds_read2_b32 v[12:13], v11 offset0:0 offset1:1
    ds_read_b32 v14, v11 offset:8
    ds_read_b32 v15, v10
    v_lshrrev_b32 v16, 5, v1
    v_mul_u32_u24 v16, 320, v16
    v_and_b32 v17, 15, v1
    v_lshl_add_u32 v16, v17, 5, v16
    v_bfe_u32 v17, v1, 4, 1
    v_lshl_add_u32 v16, v17, 4, v16
    s_mul_i32 s8, s3, 640
    v_add_u32 v16, s8, v16
    s_waitcnt lgkmcnt(0)
    v_perm_b32 v9, v12, v12, s73
    v_and_b32 v28, v9, v3
    v_and_b32 v29, v9, v4
    v_and_b32 v30, v9, v5
    v_and_b32 v31, v9, v6
    s_nop 1
    v_mfma_f32_16x16x32_bf16 v[64:67], v[28:31], v[84:87], 0
    v_perm_b32 v9, v12, v12, s74
    v_and_b32 v32, v9, v3
    v_and_b32 v33, v9, v4
    v_and_b32 v34, v9, v5
    v_and_b32 v35, v9, v6
    s_nop 1
    v_mfma_f32_16x16x32_bf16 v[64:67], v[32:35], v[88:91], v[64:67]
    v_perm_b32 v9, v13, v13, s73
    v_and_b32 v28, v9, v3
    v_and_b32 v29, v9, v4
    v_and_b32 v30, v9, v5
    v_and_b32 v31, v9, v6
    s_nop 1
    v_mfma_f32_16x16x32_bf16 v[64:67], v[28:31], v[92:95], v[64:67]
    v_perm_b32 v9, v13, v13, s74
    v_and_b32 v32, v9, v3
    v_and_b32 v33, v9, v4
    v_and_b32 v34, v9, v5
    v_and_b32 v35, v9, v6
    s_nop 1
    v_mfma_f32_16x16x32_bf16 v[64:67], v[32:35], v[96:99], v[64:67]
    v_perm_b32 v9, v14, v14, s73
    v_and_b32 v28, v9, v3
    v_and_b32 v29, v9, v4
    v_and_b32 v30, v9, v5
    v_and_b32 v31, v9, v6
    s_nop 1
    v_mfma_f32_16x16x32_bf16 v[64:67], v[28:31], v[100:103], v[64:67]
    v_perm_b32 v9, v14, v14, s74
    v_and_b32 v32, v9, v3
    v_and_b32 v33, v9, v4
    v_and_b32 v34, v9, v5
    v_and_b32 v35, v9, v6
    s_nop 1
    v_mfma_f32_16x16x32_bf16 v[64:67], v[32:35], v[104:107], v[64:67]
    s_cmp_lt_u32 s3, 6
    s_cbranch_scc0 L_nodn2
    v_perm_b32 v9, v15, v15, s73
    v_and_b32 v28, v9, v3
    v_and_b32 v29, v9, v4
    v_and_b32 v30, v9, v5
    v_and_b32 v31, v9, v6
    s_nop 1
    v_mfma_f32_16x16x32_bf16 v[64:67], v[28:31], v[108:111], v[64:67]
    v_perm_b32 v9, v15, v15, s74
    v_and_b32 v32, v9, v3
    v_and_b32 v33, v9, v4
    v_and_b32 v34, v9, v5
    v_and_b32 v35, v9, v6
    s_nop 1
    v_mfma_f32_16x16x32_bf16 v[64:67], v[32:35], v[112:115], v[64:67]
L_nodn2:
    s_nop 7
    s_mov_b32 exec_lo, 0x03ff03ff
    s_mov_b32 exec_hi, 0x03ff03ff
    ds_write_b128 v16, v[64:67] offset:25600
    s_mov_b64 exec, -1
    s_lshl_b32 s8, s5, 5
    s_mul_i32 s78, s8, 1280
    s_add_u32 s78, s78, 1839104
    s_mul_i32 s9, s4, 1280
    s_add_u32 s9, s9, s78
    s_waitcnt lgkmcnt(0)
    s_barrier
    s_cmp_lt_u32 s3, 2
    s_cbranch_scc0 L_fin
    v_lshlrev_b32 v9, 3, v0
    ds_read_b64 v[176:177], v9 offset:25600
    ds_read_b64 v[178:179], v9 offset:26240
    ds_read_b64 v[180:181], v9 offset:26880
    ds_read_b64 v[182:183], v9 offset:27520
    ds_read_b64 v[184:185], v9 offset:28160
    ds_read_b64 v[186:187], v9 offset:28800
    ds_read_b64 v[188:189], v9 offset:29440
    ds_read_b64 v[190:191], v9 offset:30080
    v_mov_b32 v13, s7
    v_mov_b32 v15, s7
    v_lshlrev_b32 v10, 4, v0
    s_waitcnt lgkmcnt(0)
    v_pk_add_f32 v[176:177], v[176:177], v[184:185]
    v_pk_add_f32 v[178:179], v[178:179], v[186:187]
    v_pk_add_f32 v[180:181], v[180:181], v[188:189]
    v_pk_add_f32 v[182:183], v[182:183], v[190:191]
    v_pk_add_f32 v[176:177], v[176:177], v[180:181]
    v_pk_add_f32 v[178:179], v[178:179], v[182:183]
    v_add_f32 v12, v176, v178
    v_add_f32 v14, v177, v179
    v_cmp_gt_u32 vcc, 80, v0
    s_and_b64 exec, exec, vcc
    buffer_store_dwordx4 v[12:15], v10, s[60:63], s9 offen sc1
    s_endpgm
L_fin:
    s_cmp_eq_u32 s3, 2
    s_cbranch_scc0 L_end
    s_cmp_lt_u32 s4, 16
    s_cbranch_scc0 L_end
    s_and_b32 s8, s4, 1
    s_mul_i32 s8, s8, 640
    s_lshr_b32 s9, s4, 1
    s_mul_i32 s9, s9, 80
    s_add_u32 s8, s8, s9
    s_add_u32 s78, s78, s8
    s_add_u32 s79, s78, 10240
    s_add_u32 s80, s78, 20480
    s_add_u32 s81, s78, 30720
    v_lshrrev_b32 v9, 3, v1
    v_mul_u32_u24 v9, 1280, v9
    v_and_b32 v10, 7, v1
    v_lshl_add_u32 v9, v10, 4, v9
    s_mov_b32 s82, 0x1f1f1f1f
    s_mov_b32 s83, 0x1f1f1f1f
L_g3l:
    s_mov_b64 exec, s[82:83]
    buffer_load_dwordx4 v[176:179], v9, s[60:63], s78 offen sc1
    buffer_load_dwordx4 v[180:183], v9, s[60:63], s79 offen sc1
    buffer_load_dwordx4 v[184:187], v9, s[60:63], s80 offen sc1
    buffer_load_dwordx4 v[188:191], v9, s[60:63], s81 offen sc1
    s_waitcnt vmcnt(0)
    v_cmpx_eq_u32 vcc, s7, v177
    v_cmpx_eq_u32 vcc, s7, v179
    v_cmpx_eq_u32 vcc, s7, v181
    v_cmpx_eq_u32 vcc, s7, v183
    v_cmpx_eq_u32 vcc, s7, v185
    v_cmpx_eq_u32 vcc, s7, v187
    v_cmpx_eq_u32 vcc, s7, v189
    v_cmpx_eq_u32 vcc, s7, v191
    s_cmp_eq_u64 exec, s[82:83]
    s_mov_b64 exec, -1
    s_cbranch_scc1 L_g3ok
    s_sub_u32 s15, s15, 1
    s_cmp_lg_u32 s15, 0
    s_cbranch_scc1 L_g3l
L_g3ok:
    v_add_f32 v176, v176, v180
    v_add_f32 v184, v184, v188
    v_add_f32 v178, v178, v182
    v_add_f32 v186, v186, v190
    v_add_f32 v176, v176, v184
    v_add_f32 v178, v178, v186
    s_nop 0
    v_add_f32_dpp v176, v176, v176 row_ror:8 row_mask:0xf bank_mask:0xf
    v_mov_b32 v11, v176
    s_nop 1
    v_permlane16_swap_b32 v11, v176
    v_add_f32 v176, v176, v11
    v_mov_b32 v11, v176
    s_nop 1
    v_permlane32_swap_b32 v11, v176
    v_add_f32 v176, v176, v11
    v_add_f32_dpp v178, v178, v178 row_ror:8 row_mask:0xf bank_mask:0xf
    v_mov_b32 v12, v178
    s_nop 1
    v_permlane16_swap_b32 v12, v178
    v_add_f32 v178, v178, v12
    v_mov_b32 v12, v178
    s_nop 1
    v_permlane32_swap_b32 v12, v178
    v_add_f32 v178, v178, v12
    v_lshlrev_b32 v11, 16, v27
    v_and_b32 v12, s95, v27
    v_add_f32 v11, v11, v176
    v_add_f32 v12, v12, v178
    v_cvt_pk_bf16_f32 v11, v11, v12
    s_mov_b32 s68, s34
    s_mov_b32 s69, s35
    s_mov_b32 s70, 2560
    s_mov_b32 s71, 0x20000
    v_lshlrev_b32 v10, 2, v10
    s_mov_b64 exec, 0x1f
    buffer_store_dword v11, v10, s[68:71], s84 offen
    s_cmp_eq_u32 s2, 0
    s_cbranch_scc0 L_fin2
    s_mov_b64 exec, 1
    v_mov_b32 v13, s7
    v_mov_b32 v14, 0
    buffer_store_dword v13, v14, s[60:63], 0 offen sc1
L_fin2:
    s_mov_b64 exec, -1
L_end:
L_exit:
    s_endpgm
.section .rodata,"a"
.p2align 6
.amdhsa_kernel parallel_sum__mha_block_cached__geglu_ffn__decode_kernel
  .amdhsa_next_free_vgpr 256
  .amdhsa_next_free_sgpr 102
  .amdhsa_accum_offset 256
  .amdhsa_group_segment_fixed_size 0
  .amdhsa_kernarg_size 96
  .amdhsa_user_sgpr_count 2
  .amdhsa_user_sgpr_kernarg_segment_ptr 1
  .amdhsa_system_sgpr_workgroup_id_x 1
.end_amdhsa_kernel
```
